```python
import torch

def _softmax(x, axis=-1):
    return torch.softmax(x, dim=axis)
def _gelu(x):
    return torch.nn.functional.gelu(x, approximate="tanh")
def _silu(x):
    return torch.nn.functional.silu(x)
def _sigmoid(x):
    return torch.sigmoid(x)
def _layernorm(x, axis=-1, eps=1e-5):
    m = x.mean(dim=axis, keepdim=True)
    v = x.var(dim=axis, keepdim=True, unbiased=False)
    return (x - m) / torch.sqrt(v + eps)
def _scatter_add(tgt, idx, src, axis=0):
    return tgt.clone().index_add_(axis, idx, src)
def _segment_sum(src, seg, n):
    out = torch.zeros((n,) + src.shape[1:], dtype=src.dtype)
    return out.index_add_(0, seg, src)
def _pad(x, pw):
    flat = tuple(v for pair in reversed(pw) for v in pair)
    return torch.nn.functional.pad(x, flat)

kernel_name = 'parallel_sum__sliding_block_cached__glu_gated_swiglu__decode'

def setup_inputs():

    _w = (lambda a: (lambda t: t.to(torch.bfloat16) if t.is_floating_point() else t)(torch.as_tensor(a)))
    def _A_setup():
        B, Sq, D = 2, 1, 576
        Hq, Hkv, Sk, Dh = 32, 16, 32768, 128
        assert Hq % Hkv == 0, (Hq, Hkv)
        return {
            "x": _w((lambda *s: torch.randn(*s, dtype=torch.bfloat16) * 0.05)(B, Sq, D)),
            "k_cache": _w((lambda *s: torch.randn(*s, dtype=torch.bfloat16) * 1.6)(B, Hkv, Sk, Dh)),
            "v_cache": _w((lambda *s: torch.randn(*s, dtype=torch.bfloat16) * 0.8)(B, Hkv, Sk, Dh)),
            "wq": _w((lambda *s: torch.randn(*s, dtype=torch.bfloat16) * 1.6)(D, Hq * Dh) * (D ** -0.5)),
            "wo": _w((lambda *s: torch.randn(*s, dtype=torch.bfloat16) * 0.8)(Hq * Dh, D) * ((Hq * Dh) ** -0.5)),
        }
    _A_in = _A_setup()

    def _B_setup():
        B, S, D, F = 2, 1, 576, 4608
        return {
            "x": _w((lambda *s: torch.randn(*s, dtype=torch.bfloat16) * 0.05)(B, S, D)),
            "w1": _w((lambda *s: torch.randn(*s, dtype=torch.bfloat16) * 0.4)(D, F) * (2.0 / D) ** 0.5),
            "w3": _w((lambda *s: torch.randn(*s, dtype=torch.bfloat16) * 0.4)(D, F) * (2.0 / D) ** 0.5),
            "w2": _w((lambda *s: torch.randn(*s, dtype=torch.bfloat16) * 0.4)(F, D) * (2.0 / F) ** 0.5),
        }
    _B_in = _B_setup()

    return {
        "A_x": _A_in["x"],
        "A_k_cache": _A_in["k_cache"],
        "A_v_cache": _A_in["v_cache"],
        "A_wq": _A_in["wq"],
        "A_wo": _A_in["wo"],
        "B_x": _B_in["x"],
        "B_w1": _B_in["w1"],
        "B_w3": _B_in["w3"],
        "B_w2": _B_in["w2"],
    }

def reference(A_x, A_k_cache, A_v_cache, A_wq, A_wo, B_x, B_w1, B_w3, B_w2):
    def _A_ref(x, k_cache, v_cache, wq, wo):
        B, Sq, D = x.shape
        Hq, Dh = 32, 128
        Hkv, Sk = k_cache.shape[1], k_cache.shape[2]
        W = min(4096, max(256, Sk // 4))
        rep = Hq // Hkv
        q = (lambda x, *d: x.permute(*d))((x @ wq).reshape(B, Sq, Hq, Dh), 0, 2, 1, 3)
        k = (lambda x, n, axis: torch.repeat_interleave(x, n, dim=axis))(k_cache[:, :, Sk - W:, :], rep, axis=1)
        v = (lambda x, n, axis: torch.repeat_interleave(x, n, dim=axis))(v_cache[:, :, Sk - W:, :], rep, axis=1)
        scores = torch.einsum("bhqd,bhkd->bhqk", q, k) * (Dh ** -0.5)
        p = _softmax(scores, axis=-1)
        o = torch.einsum("bhqk,bhkd->bhqd", p, v)
        return (lambda x, *d: x.permute(*d))(o, 0, 2, 1, 3).reshape(B, Sq, Hq * Dh) @ wo

    def _B_ref(x, w1, w3, w2):
        gate = torch.einsum("bsd,df->bsf", x, w1)
        up = torch.einsum("bsd,df->bsf", x, w3)
        h = _silu(gate) * up
        out = torch.einsum("bsf,fd->bsd", h, w2)
        return out

    x = A_x
    xn = _layernorm(x, axis=-1)
    return x + _A_ref(xn, A_k_cache, A_v_cache, A_wq, A_wo) + _B_ref(xn, B_w1, B_w3, B_w2)
```

```asm
; @launch grid=(256,1,1) block=(768,1,1) lds=30720
.amdgcn_target "amdgcn-amd-amdhsa--gfx950"
.text
.globl parallel_sum__sliding_block_cached__glu_gated_swiglu__decode_kernel
.p2align 8
.type parallel_sum__sliding_block_cached__glu_gated_swiglu__decode_kernel,@function
parallel_sum__sliding_block_cached__glu_gated_swiglu__decode_kernel:
    s_cmp_ge_u32 s2, 256
    s_cbranch_scc1 L_end
    s_load_dwordx16 s[16:31], s[0:1], 0
    s_load_dwordx8 s[32:39], s[0:1], 64
    v_lshrrev_b32 v1, 6, v0
    v_and_b32 v0, 63, v0
    v_readfirstlane_b32 s3, v1
    v_and_b32 v6, 15, v0
    v_lshrrev_b32 v7, 4, v0
    v_lshrrev_b32 v2, 2, v6
    v_lshlrev_b32 v2, 8, v2
    v_bfe_u32 v3, v6, 1, 1
    v_lshl_add_u32 v2, v3, 10, v2
    v_and_b32 v3, 1, v6
    v_lshl_add_u32 v2, v3, 6, v2
    v_lshl_add_u32 v2, v7, 4, v2
    s_add_u32 s3, s3, 4
    s_cmp_ge_u32 s3, 12
    s_cselect_b32 s5, 12, 0
    s_sub_u32 s3, s3, s5
    s_lshr_b32 s6, s2, 3
    s_and_b32 s5, s2, 7
    s_lshr_b32 s54, s2, 7
    s_lshl1_add_u32 s54, s5, s54
    s_and_b32 s55, s6, 15
    s_lshr_b32 s4, s55, 3
    s_lshl4_add_u32 s4, s4, s54
    s_lshl_b32 s4, s4, 6
    s_and_b32 s5, s55, 7
    s_add_u32 s4, s4, s5
    s_lshl3_add_u32 s4, s4, s3
    s_addk_i32 s4, 444
    s_lshl_b32 s4, s4, 14
    s_lshl1_add_u32 s6, s3, s6
    s_lshl_b32 s6, s6, 11
    s_movk_i32 s10, 0x4000
    s_mov_b32 s11, 0x20000
    s_movk_i32 s7, 0x3800
    s_and_b32 s46, s6, s7
    s_addk_i32 s6, 0x800
    s_and_b32 s47, s6, s7
    s_cmp_lt_u32 s3, 4
    s_cbranch_scc1 L_aux
    s_waitcnt lgkmcnt(0)
    s_add_u32 s8, s18, s4
    s_addc_u32 s9, s19, 0
    buffer_load_dwordx4 v[8:11], v2, s[8:11], s46 offen offset:0 nt
    buffer_load_dwordx4 v[12:15], v2, s[8:11], s46 offen offset:128 nt
    buffer_load_dwordx4 v[16:19], v2, s[8:11], s47 offen offset:0 nt
    v_mov_b32 v1, 0
    v_mov_b32 v138, 0
    v_mov_b32 v139, 0
    s_lshl_b32 s58, s3, 9
    v_lshl_add_u32 v136, v0, 3, s58
    ds_write_b64 v136, v[138:139] offset:5120
    s_mov_b32 s43, 0xffff0000
    s_mov_b32 s60, s38
    s_mov_b32 s61, s39
    s_mov_b32 s62, 2097152
    s_mov_b32 s63, s11
    s_add_u32 s12, s20, s4
    s_addc_u32 s13, s21, 0
    s_mov_b32 s14, s10
    s_mov_b32 s15, s11
    s_addk_i32 s6, 0x800
    s_and_b32 s48, s6, s7
    s_addk_i32 s6, 0x800
    s_and_b32 s49, s6, s7
    s_addk_i32 s6, 0x800
    s_and_b32 s50, s6, s7
    s_addk_i32 s6, 0x800
    s_and_b32 s51, s6, s7
    s_addk_i32 s6, 0x800
    s_and_b32 s52, s6, s7
    s_addk_i32 s6, 0x800
    s_and_b32 s53, s6, s7
    v_lshlrev_b32 v4, 4, v0
    s_waitcnt lgkmcnt(0)
    s_load_dword s40, s[38:39], 0
    s_barrier
    v_bfe_u32 v5, v0, 3, 1
    v_mul_u32_u24 v5, 0x202, v5
    v_add_u32 v5, 0x100, v5
    v_lshlrev_b32 v3, 16, v5
    v_or_b32 v3, 0x0c0c, v3
    v_or_b32 v5, 0x0c0c0000, v5
    s_mov_b32 vcc_lo, 0xaaaaaaaa
    s_mov_b32 vcc_hi, 0xaaaaaaaa
    v_cndmask_b32 v5, v5, v3, vcc
    v_mov_b32 v3, 0x0c0c0c0c
    v_bfe_u32 v136, v0, 1, 2
    v_cmp_eq_u32 s[24:25], 0, v136
    v_cmp_eq_u32 s[26:27], 1, v136
    v_cmp_eq_u32 s[28:29], 2, v136
    v_cmp_eq_u32 s[30:31], 3, v136
    v_cndmask_b32 v160, v3, v5, s[24:25]
    v_cndmask_b32 v161, v3, v5, s[26:27]
    v_cndmask_b32 v162, v3, v5, s[28:29]
    v_cndmask_b32 v163, v3, v5, s[30:31]
    v_bfe_u32 v5, v0, 1, 1
    v_lshlrev_b32 v5, 8, v5
    v_and_b32 v3, 1, v0
    v_lshl_add_u32 v5, v3, 6, v5
    v_lshl_add_u32 v7, v7, 4, v5
    v_bfe_u32 v6, v0, 2, 2
    v_mov_b32 v136, 512
    v_cmp_eq_u32 s[24:25], 0, v6
    v_cmp_eq_u32 s[26:27], 1, v6
    v_cmp_eq_u32 s[28:29], 2, v6
    v_cmp_eq_u32 s[30:31], 3, v6
    v_cndmask_b32 v164, v136, v7, s[24:25]
    v_cndmask_b32 v165, v136, v7, s[26:27]
    v_cndmask_b32 v166, v136, v7, s[28:29]
    v_cndmask_b32 v167, v136, v7, s[30:31]
    s_mov_b32 s44, 0x3db504f3
    s_mov_b32 s45, 0x3fb8aa3b
    s_waitcnt vmcnt(2)
    buffer_load_dwordx4 v[20:23], v2, s[8:11], s47 offen offset:128 nt
    s_waitcnt vmcnt(2)
    buffer_load_dwordx4 v[24:27], v2, s[8:11], s48 offen offset:0 nt
    s_waitcnt vmcnt(2)
    buffer_load_dwordx4 v[28:31], v2, s[8:11], s48 offen offset:128 nt
    s_waitcnt vmcnt(2)
    buffer_load_dwordx4 v[32:35], v2, s[8:11], s49 offen offset:0 nt
    s_waitcnt vmcnt(2)
    buffer_load_dwordx4 v[36:39], v2, s[8:11], s49 offen offset:128 nt
    s_waitcnt vmcnt(2)
    buffer_load_dwordx4 v[40:43], v2, s[8:11], s50 offen offset:0 nt
    s_waitcnt vmcnt(2)
    buffer_load_dwordx4 v[44:47], v2, s[8:11], s50 offen offset:128 nt
    s_waitcnt vmcnt(2)
    buffer_load_dwordx4 v[48:51], v2, s[8:11], s51 offen offset:0 nt
    s_waitcnt vmcnt(2)
    buffer_load_dwordx4 v[52:55], v2, s[8:11], s51 offen offset:128 nt
    s_waitcnt vmcnt(2)
    buffer_load_dwordx4 v[56:59], v2, s[8:11], s52 offen offset:0 nt
    s_waitcnt vmcnt(2)
    buffer_load_dwordx4 v[60:63], v2, s[8:11], s52 offen offset:128 nt
    s_waitcnt vmcnt(2)
    buffer_load_dwordx4 v[64:67], v2, s[8:11], s53 offen offset:0 nt
    s_waitcnt vmcnt(2)
    buffer_load_dwordx4 v[68:71], v2, s[8:11], s53 offen offset:128 nt
    s_waitcnt vmcnt(2)
    buffer_load_dwordx4 v[72:75], v4, s[12:15], s46 offen offset:0 nt
    s_waitcnt vmcnt(2)
    buffer_load_dwordx4 v[76:79], v4, s[12:15], s46 offen offset:1024 nt
    s_waitcnt vmcnt(2)
    buffer_load_dwordx4 v[80:83], v4, s[12:15], s47 offen offset:0 nt
    v_mov_b32 v5, 1
    s_mov_b64 exec, 1
    ds_add_u32 v1, v5 offset:5400
    s_mov_b64 exec, -1
    s_waitcnt vmcnt(2)
    buffer_load_dwordx4 v[84:87], v4, s[12:15], s47 offen offset:1024 nt
    s_waitcnt vmcnt(2)
    buffer_load_dwordx4 v[88:91], v4, s[12:15], s48 offen offset:0 nt
    s_waitcnt vmcnt(2)
    buffer_load_dwordx4 v[92:95], v4, s[12:15], s48 offen offset:1024 nt
    s_waitcnt vmcnt(2)
    buffer_load_dwordx4 v[96:99], v4, s[12:15], s49 offen offset:0 nt
    s_waitcnt vmcnt(2)
    buffer_load_dwordx4 v[100:103], v4, s[12:15], s49 offen offset:1024 nt
    s_waitcnt vmcnt(2)
    buffer_load_dwordx4 v[104:107], v4, s[12:15], s50 offen offset:0 nt
    s_waitcnt vmcnt(2)
    buffer_load_dwordx4 v[108:111], v4, s[12:15], s50 offen offset:1024 nt
    buffer_load_dwordx4 v[112:115], v4, s[12:15], s51 offen offset:0 nt
    buffer_load_dwordx4 v[116:119], v4, s[12:15], s51 offen offset:1024 nt
    buffer_load_dwordx4 v[120:123], v4, s[12:15], s52 offen offset:0 nt
    buffer_load_dwordx4 v[124:127], v4, s[12:15], s52 offen offset:1024 nt
    buffer_load_dwordx4 v[128:131], v4, s[12:15], s53 offen offset:0 nt
    buffer_load_dwordx4 v[132:135], v4, s[12:15], s53 offen offset:1024 nt
    v_mov_b32 v5, 1
    s_mov_b64 exec, 1
    ds_add_u32 v1, v5 offset:5376
    s_mov_b64 exec, -1
L_wq:
    ds_read_b32 v6, v1 offset:5388
    s_waitcnt lgkmcnt(0)
    v_readfirstlane_b32 s59, v6
    s_nop 0
    s_cmp_ge_u32 s59, 1
    s_cbranch_scc1 L_wq_ok
    s_sleep 2
    s_branch L_wq
L_wq_ok:
    ds_read_b128 v[136:139], v164 offset:4608
    ds_read_b128 v[140:143], v164 offset:4736
    ds_read_b128 v[144:147], v165 offset:4608
    ds_read_b128 v[148:151], v165 offset:4736
    s_waitcnt lgkmcnt(2)
    v_mfma_f32_16x16x32_bf16 v[152:155], v[8:11], v[136:139], 0
    v_mfma_f32_16x16x32_bf16 v[152:155], v[12:15], v[140:143], v[152:155]
    v_mfma_f32_16x16x32_bf16 v[156:159], v[16:19], v[136:139], 0
    v_mfma_f32_16x16x32_bf16 v[156:159], v[20:23], v[140:143], v[156:159]
    ds_read_b128 v[136:139], v166 offset:4608
    ds_read_b128 v[140:143], v166 offset:4736
    s_waitcnt lgkmcnt(2)
    v_mfma_f32_16x16x32_bf16 v[152:155], v[24:27], v[144:147], v[152:155]
    v_mfma_f32_16x16x32_bf16 v[152:155], v[28:31], v[148:151], v[152:155]
    v_mfma_f32_16x16x32_bf16 v[156:159], v[32:35], v[144:147], v[156:159]
    v_mfma_f32_16x16x32_bf16 v[156:159], v[36:39], v[148:151], v[156:159]
    ds_read_b128 v[144:147], v167 offset:4608
    ds_read_b128 v[148:151], v167 offset:4736
    s_waitcnt lgkmcnt(2)
    v_mfma_f32_16x16x32_bf16 v[152:155], v[40:43], v[136:139], v[152:155]
    v_mfma_f32_16x16x32_bf16 v[152:155], v[44:47], v[140:143], v[152:155]
    v_mfma_f32_16x16x32_bf16 v[156:159], v[48:51], v[136:139], v[156:159]
    v_mfma_f32_16x16x32_bf16 v[156:159], v[52:55], v[140:143], v[156:159]
    s_waitcnt lgkmcnt(0)
    v_mfma_f32_16x16x32_bf16 v[152:155], v[56:59], v[144:147], v[152:155]
    v_mfma_f32_16x16x32_bf16 v[152:155], v[60:63], v[148:151], v[152:155]
    v_mfma_f32_16x16x32_bf16 v[156:159], v[64:67], v[144:147], v[156:159]
    v_mfma_f32_16x16x32_bf16 v[156:159], v[68:71], v[148:151], v[156:159]
    s_sub_u32 s4, s3, 4
    s_lshl_b32 s5, s4, 2
    v_lshl_add_u32 v3, v0, 5, s5
    s_add_u32 s40, s40, 1
    s_movk_i32 s41, 0x3ff
    s_and_b32 s42, s40, s41
    v_mov_b32 v4, s42
    v_cndmask_b32 v152, v152, v155, vcc
    v_cndmask_b32 v153, v154, v153, vcc
    v_cndmask_b32 v156, v156, v159, vcc
    v_cndmask_b32 v157, v158, v157, vcc
    v_add_f32_dpp v136, v153, v152 quad_perm:[1,0,3,2] row_mask:0xf bank_mask:0xf
    s_nop 0
    v_add_f32_dpp v137, v157, v156 quad_perm:[1,0,3,2] row_mask:0xf bank_mask:0xf
    v_cvt_pk_bf16_f32 v2, v136, v137
    v_lshlrev_b32 v136, 16, v2
    v_and_b32 v137, s43, v2
    v_mul_f32 v136, s44, v136
    v_mul_f32 v137, s44, v137
    v_cvt_pk_bf16_f32 v2, v136, v137
    v_lshlrev_b32 v136, 16, v2
    v_and_b32 v137, s43, v2
    v_max_f32 v6, v136, v137
    s_nop 1
    v_max_f32_dpp v6, v6, v6 quad_perm:[1,0,3,2] row_mask:0xf bank_mask:0xf
    s_nop 1
    v_max_f32_dpp v6, v6, v6 row_ror:4 row_mask:0xf bank_mask:0xf
    s_nop 1
    v_max_f32_dpp v6, v6, v6 row_ror:8 row_mask:0xf bank_mask:0xf
    v_mov_b32 v2, v6
    s_nop 1
    v_permlane16_swap_b32 v6, v2
    v_max_f32 v6, v6, v2
    v_mov_b32 v2, v6
    s_nop 1
    v_permlane32_swap_b32 v6, v2
    v_max_f32 v6, v6, v2
    v_mul_f32 v6, s45, v6
    v_fma_f32 v136, v136, s45, -v6
    v_fma_f32 v137, v137, s45, -v6
    v_exp_f32 v136, v136
    v_exp_f32 v137, v137
    v_mov_b32 v5, 1
    v_mov_b32_dpp v2, v136 quad_perm:[2,3,0,1] row_mask:0xf bank_mask:0xf
    v_mov_b32_dpp v152, v137 quad_perm:[2,3,0,1] row_mask:0xf bank_mask:0xf
    v_add_f32 v7, v136, v137
    v_cvt_pk_bf16_f32 v136, v136, v2
    v_cvt_pk_bf16_f32 v137, v137, v152
    v_add_f32_dpp v7, v7, v7 quad_perm:[1,0,3,2] row_mask:0xf bank_mask:0xf
    s_nop 1
    v_add_f32_dpp v7, v7, v7 row_ror:4 row_mask:0xf bank_mask:0xf
    s_nop 1
    v_add_f32_dpp v7, v7, v7 row_ror:8 row_mask:0xf bank_mask:0xf
    v_mov_b32 v2, v7
    s_nop 1
    v_permlane16_swap_b32 v7, v2
    v_add_f32 v7, v7, v2
    v_mov_b32 v2, v7
    s_nop 1
    v_permlane32_swap_b32 v7, v2
    v_add_f32 v7, v7, v2
    s_mov_b64 exec, 5
    ds_write_b32 v3, v6 offset:5632
    ds_write_b32 v3, v7 offset:5664
    s_mov_b64 exec, 1
    ds_add_u32 v1, v5 offset:5396
    s_mov_b64 exec, -1
    s_nop 0
    v_mov_b32_dpp v138, v136 row_newbcast:0 row_mask:0xf bank_mask:0xf
    v_perm_b32 v8, v138, v138, v160
    v_perm_b32 v9, v138, v138, v161
    v_perm_b32 v10, v138, v138, v162
    v_perm_b32 v11, v138, v138, v163
    v_mov_b32_dpp v139, v136 row_newbcast:1 row_mask:0xf bank_mask:0xf
    v_perm_b32 v12, v139, v139, v160
    v_perm_b32 v13, v139, v139, v161
    v_perm_b32 v14, v139, v139, v162
    v_perm_b32 v15, v139, v139, v163
    v_mov_b32_dpp v140, v137 row_newbcast:0 row_mask:0xf bank_mask:0xf
    v_perm_b32 v16, v140, v140, v160
    v_perm_b32 v17, v140, v140, v161
    v_perm_b32 v18, v140, v140, v162
    v_perm_b32 v19, v140, v140, v163
    v_mov_b32_dpp v141, v137 row_newbcast:1 row_mask:0xf bank_mask:0xf
    v_perm_b32 v20, v141, v141, v160
    v_perm_b32 v21, v141, v141, v161
    v_perm_b32 v22, v141, v141, v162
    v_perm_b32 v23, v141, v141, v163
    v_mov_b32_dpp v138, v136 row_newbcast:4 row_mask:0xf bank_mask:0xf
    v_perm_b32 v24, v138, v138, v160
    v_perm_b32 v25, v138, v138, v161
    v_perm_b32 v26, v138, v138, v162
    v_perm_b32 v27, v138, v138, v163
    v_mov_b32_dpp v139, v136 row_newbcast:5 row_mask:0xf bank_mask:0xf
    v_perm_b32 v28, v139, v139, v160
    v_perm_b32 v29, v139, v139, v161
    v_perm_b32 v30, v139, v139, v162
    v_perm_b32 v31, v139, v139, v163
    v_mov_b32_dpp v140, v137 row_newbcast:4 row_mask:0xf bank_mask:0xf
    v_perm_b32 v32, v140, v140, v160
    v_perm_b32 v33, v140, v140, v161
    v_perm_b32 v34, v140, v140, v162
    v_perm_b32 v35, v140, v140, v163
    v_mov_b32_dpp v141, v137 row_newbcast:5 row_mask:0xf bank_mask:0xf
    v_perm_b32 v36, v141, v141, v160
    v_perm_b32 v37, v141, v141, v161
    v_perm_b32 v38, v141, v141, v162
    v_perm_b32 v39, v141, v141, v163
    v_mov_b32_dpp v138, v136 row_newbcast:8 row_mask:0xf bank_mask:0xf
    v_perm_b32 v40, v138, v138, v160
    v_perm_b32 v41, v138, v138, v161
    v_perm_b32 v42, v138, v138, v162
    v_perm_b32 v43, v138, v138, v163
    v_mov_b32_dpp v139, v136 row_newbcast:9 row_mask:0xf bank_mask:0xf
    v_perm_b32 v44, v139, v139, v160
    v_perm_b32 v45, v139, v139, v161
    v_perm_b32 v46, v139, v139, v162
    v_perm_b32 v47, v139, v139, v163
    v_mov_b32_dpp v140, v137 row_newbcast:8 row_mask:0xf bank_mask:0xf
    v_perm_b32 v48, v140, v140, v160
    v_perm_b32 v49, v140, v140, v161
    v_perm_b32 v50, v140, v140, v162
    v_perm_b32 v51, v140, v140, v163
    v_mov_b32_dpp v141, v137 row_newbcast:9 row_mask:0xf bank_mask:0xf
    v_perm_b32 v52, v141, v141, v160
    v_perm_b32 v53, v141, v141, v161
    v_perm_b32 v54, v141, v141, v162
    v_perm_b32 v55, v141, v141, v163
    v_mov_b32_dpp v138, v136 row_newbcast:12 row_mask:0xf bank_mask:0xf
    v_perm_b32 v56, v138, v138, v160
    v_perm_b32 v57, v138, v138, v161
    v_perm_b32 v58, v138, v138, v162
    v_perm_b32 v59, v138, v138, v163
    v_mov_b32_dpp v139, v136 row_newbcast:13 row_mask:0xf bank_mask:0xf
    v_perm_b32 v60, v139, v139, v160
    v_perm_b32 v61, v139, v139, v161
    v_perm_b32 v62, v139, v139, v162
    v_perm_b32 v63, v139, v139, v163
    v_mov_b32_dpp v140, v137 row_newbcast:12 row_mask:0xf bank_mask:0xf
    v_perm_b32 v64, v140, v140, v160
    v_perm_b32 v65, v140, v140, v161
    v_perm_b32 v66, v140, v140, v162
    v_perm_b32 v67, v140, v140, v163
    v_mov_b32_dpp v141, v137 row_newbcast:13 row_mask:0xf bank_mask:0xf
    v_perm_b32 v68, v141, v141, v160
    v_perm_b32 v69, v141, v141, v161
    v_perm_b32 v70, v141, v141, v162
    v_perm_b32 v71, v141, v141, v163
    v_mfma_f32_16x16x32_bf16 v[164:167], v[8:11], v[72:75], 0
    v_mfma_f32_16x16x32_bf16 v[164:167], v[12:15], v[76:79], v[164:167]
    v_mfma_f32_16x16x32_bf16 v[164:167], v[16:19], v[80:83], v[164:167]
    v_mfma_f32_16x16x32_bf16 v[164:167], v[20:23], v[84:87], v[164:167]
    v_mfma_f32_16x16x32_bf16 v[164:167], v[24:27], v[88:91], v[164:167]
    v_mfma_f32_16x16x32_bf16 v[164:167], v[28:31], v[92:95], v[164:167]
    v_mfma_f32_16x16x32_bf16 v[164:167], v[32:35], v[96:99], v[164:167]
    s_lshl_b32 s6, s54, 14
    s_lshl_b32 s7, s55, 8
    s_add_u32 s6, s6, s7
    s_add_u32 s6, s6, 393216
    s_lshl_b32 s7, s54, 9
    s_lshl4_add_u32 s7, s55, s7
    s_add_u32 s7, s7, 4096
    s_mov_b32 s56, 1048576
    v_lshrrev_b32 v2, 5, v0
    v_lshlrev_b32 v2, 6, v2
    v_lshl_add_u32 v153, v2, 2, s7
    v_lshl_add_u32 v152, v2, 7, s6
    v_bfe_u32 v5, v0, 3, 1
    v_lshl_add_u32 v152, v5, 12, v152
    v_and_b32 v5, 7, v0
    v_lshl_add_u32 v152, v5, 5, v152
    v_bfe_u32 v5, v0, 4, 1
    v_lshl_add_u32 v152, v5, 4, v152
    v_add_u32 v3, s5, v2
L_wm:
    ds_read_b32 v6, v1 offset:5396
    s_waitcnt lgkmcnt(0)
    v_readfirstlane_b32 s59, v6
    s_nop 0
    s_cmp_ge_u32 s59, 8
    s_cbranch_scc1 L_wm_ok
    s_sleep 1
    s_branch L_wm
L_wm_ok:
    ds_read_b128 v[136:139], v2 offset:5632
    ds_read_b128 v[140:143], v2 offset:5648
    ds_read_b32 v144, v3 offset:5632
    ds_read_b32 v145, v3 offset:5664
    s_waitcnt lgkmcnt(0)
    v_max3_f32 v148, v136, v137, v138
    v_max3_f32 v149, v139, v140, v141
    v_max3_f32 v148, v148, v142, v143
    v_max_f32 v148, v148, v149
    v_bfi_b32 v148, s41, 0, v148
    v_sub_f32 v144, v144, v148
    v_or_b32 v148, v148, v4
    v_exp_f32 v144, v144
    v_mov_b32 v150, v148
    v_mov_b32 v5, 1
    v_mul_f32 v145, v144, v145
    s_lshl_b32 s6, s5, 8
    v_lshl_add_u32 v6, v0, 4, s6
    s_mov_b32 exec_lo, 1
    s_mov_b32 exec_hi, 1
    ds_write_b32 v3, v145 offset:5760
    s_mov_b64 exec, -1
    v_lshlrev_b32 v7, 4, v0
    v_mov_b32 v145, v144
    s_setprio 3
    s_waitcnt vmcnt(8)
    v_mfma_f32_16x16x32_bf16 v[164:167], v[36:39], v[100:103], v[164:167]
    s_waitcnt vmcnt(7)
    v_mfma_f32_16x16x32_bf16 v[164:167], v[40:43], v[104:107], v[164:167]
    s_waitcnt vmcnt(6)
    v_mfma_f32_16x16x32_bf16 v[164:167], v[44:47], v[108:111], v[164:167]
    s_waitcnt vmcnt(5)
    v_mfma_f32_16x16x32_bf16 v[164:167], v[48:51], v[112:115], v[164:167]
    s_waitcnt vmcnt(4)
    v_mfma_f32_16x16x32_bf16 v[164:167], v[52:55], v[116:119], v[164:167]
    s_waitcnt vmcnt(3)
    v_mfma_f32_16x16x32_bf16 v[164:167], v[56:59], v[120:123], v[164:167]
    s_waitcnt vmcnt(2)
    v_mfma_f32_16x16x32_bf16 v[164:167], v[60:63], v[124:127], v[164:167]
    s_waitcnt vmcnt(1)
    v_mfma_f32_16x16x32_bf16 v[164:167], v[64:67], v[128:131], v[164:167]
    s_waitcnt vmcnt(0)
    v_mfma_f32_16x16x32_bf16 v[164:167], v[68:71], v[132:135], v[164:167]
    s_nop 7
    v_pk_mul_f32 v[164:165], v[164:165], v[144:145]
    v_pk_mul_f32 v[166:167], v[166:167], v[144:145]
    ds_write_b128 v6, v[164:167] offset:22528
    s_mov_b64 exec, 1
    ds_add_rtn_u32 v5, v1, v5 offset:5380
    s_mov_b64 exec, -1
    ds_read_b128 v[8:11], v7 offset:22528
    ds_read_b128 v[12:15], v7 offset:23552
    ds_read_b128 v[16:19], v7 offset:24576
    ds_read_b128 v[20:23], v7 offset:25600
    ds_read_b128 v[24:27], v7 offset:26624
    ds_read_b128 v[28:31], v7 offset:27648
    ds_read_b128 v[32:35], v7 offset:28672
    ds_read_b128 v[36:39], v7 offset:29696
    ds_read_b128 v[40:43], v2 offset:5760
    ds_read_b128 v[44:47], v2 offset:5776
    s_waitcnt lgkmcnt(10)
    v_readfirstlane_b32 s4, v5
    s_nop 0
    s_cmp_lg_u32 s4, 7
    s_cbranch_scc1 L_sdone
    s_waitcnt lgkmcnt(8)
    v_pk_add_f32 v[8:9], v[8:9], v[12:13]
    v_pk_add_f32 v[10:11], v[10:11], v[14:15]
    s_waitcnt lgkmcnt(6)
    v_pk_add_f32 v[16:17], v[16:17], v[20:21]
    v_pk_add_f32 v[18:19], v[18:19], v[22:23]
    v_pk_add_f32 v[8:9], v[8:9], v[16:17]
    v_pk_add_f32 v[10:11], v[10:11], v[18:19]
    s_waitcnt lgkmcnt(4)
    v_pk_add_f32 v[24:25], v[24:25], v[28:29]
    v_pk_add_f32 v[26:27], v[26:27], v[30:31]
    s_waitcnt lgkmcnt(2)
    v_pk_add_f32 v[32:33], v[32:33], v[36:37]
    v_pk_add_f32 v[34:35], v[34:35], v[38:39]
    v_pk_add_f32 v[24:25], v[24:25], v[32:33]
    v_pk_add_f32 v[26:27], v[26:27], v[34:35]
    v_pk_add_f32 v[156:157], v[8:9], v[24:25]
    v_pk_add_f32 v[158:159], v[10:11], v[26:27]
    v_bfi_b32 v156, s41, v4, v156
    v_bfi_b32 v157, s41, v4, v157
    v_bfi_b32 v158, s41, v4, v158
    v_bfi_b32 v159, s41, v4, v159
    buffer_store_dwordx4 v[156:159], v152, s[60:63], s56 offen
    s_waitcnt lgkmcnt(0)
    v_pk_add_f32 v[40:41], v[40:41], v[42:43]
    v_pk_add_f32 v[44:45], v[44:45], v[46:47]
    v_pk_add_f32 v[40:41], v[40:41], v[44:45]
    v_add_f32 v149, v40, v41
    v_bfi_b32 v149, s41, v4, v149
    v_mov_b32 v151, v149
    s_mov_b32 exec_lo, 1
    s_mov_b32 exec_hi, 1
    buffer_store_dwordx4 v[148:151], v153, s[60:63], s56 offen
    buffer_store_dwordx4 v[148:151], v153, s[60:63], 0 offen sc1
    s_mov_b64 exec, -1
    buffer_store_dwordx4 v[156:159], v152, s[60:63], 0 offen sc1
    v_mov_b32 v5, 1
    s_mov_b64 exec, 1
    ds_add_u32 v1, v5 offset:5380
    s_mov_b64 exec, -1
L_sdone:
    s_waitcnt lgkmcnt(0)
    s_cmp_lg_u32 s3, 4
    s_cbranch_scc1 L_end
    s_sub_u32 s4, s2, 144
    s_cmp_ge_u32 s4, 36
    s_cbranch_scc1 L_end
    v_mov_b32 v150, v4
    s_branch L_red
L_aux:
    v_mul_u32_u24 v3, 36, v0
    s_waitcnt lgkmcnt(0)
    s_setprio 3
    s_sub_u32 s4, s2, 80
    s_lshr_b32 s4, s4, 1
    s_bitcmp1_b32 s2, 0
    s_cselect_b32 s5, 88, 0
    s_add_u32 s4, s4, s5
    s_add_u32 s4, s4, 80
    s_cmp_lt_u32 s2, 80
    s_cselect_b32 s64, s2, s4
    s_lshl2_add_u32 s4, s64, s3
    s_cmp_lt_u32 s64, 168
    s_cbranch_scc1 L_u4
    s_cmp_eq_u32 s3, 3
    s_cbranch_scc1 L_nos1
    s_sub_u32 s4, s4, s64
    s_add_u32 s4, s4, 168
L_u4:
    s_mul_i32 s7, s4, 7282
    s_lshr_b32 s7, s7, 16
    s_mul_i32 s5, s7, 9
    s_sub_u32 s5, s4, s5
    s_mul_i32 s4, s7, 9
    s_lshr_b32 s4, s4, 2
    s_mul_i32 s12, s7, 3
    s_sub_u32 s12, s12, 56
    s_cmp_lt_u32 s7, 75
    s_cselect_b32 s4, s4, s12
    s_sub_u32 s65, s64, s4
    s_mul_i32 s4, s7, 43
    s_lshr_b32 s4, s4, 7
    s_add_u32 s12, s7, s4
    s_and_b32 s6, s12, 3
    s_cselect_b32 s6, 1, 0
    s_add_u32 s12, s12, s6
    s_lshl_b32 s4, s7, 2
    s_sub_u32 s4, s4, 311
    s_cmp_lt_u32 s7, 78
    s_cselect_b32 s7, s12, s4
    s_movk_i32 s6, 9216
    s_cmp_lt_u32 s7, 32
    s_cselect_b32 s6, 8192, s6
    s_cselect_b32 s8, s22, s28
    s_cselect_b32 s9, s23, s29
    s_cselect_b32 s12, 0, 32
    s_cmp_lt_u32 s7, 68
    s_cselect_b32 s8, s8, s30
    s_cselect_b32 s9, s9, s31
    s_cselect_b32 s12, s12, 0x44
    s_mul_i32 s10, s6, 576
    s_sub_u32 s4, s7, s12
    s_lshl_b32 s4, s4, 8
    s_lshl_b32 s15, s5, 6
    s_mul_i32 s12, s15, s6
    s_add_u32 s12, s12, s4
    s_lshl_b32 s13, s6, 1
    v_mul_u32_u24 v2, s13, v7
    v_lshl_add_u32 v2, v6, 4, v2
    s_mul_i32 s13, s6, 7
    v_mov_b32 v1, 0
    v_mov_b32 v138, 0
    v_mov_b32 v139, 0
    s_lshl_b32 s58, s3, 9
    v_lshl_add_u32 v136, v0, 3, s58
    ds_write_b64 v136, v[138:139] offset:5120
    s_mov_b32 s43, 0xffff0000
    s_mov_b32 s60, s38
    s_mov_b32 s61, s39
    s_mov_b32 s62, 2097152
    s_mov_b32 s63, s11
    s_waitcnt lgkmcnt(0)
    s_load_dword s40, s[38:39], 0
    s_barrier
    global_load_dwordx3 v[80:82], v3, s[16:17]
    global_load_dwordx3 v[84:86], v3, s[16:17] offset:12
    global_load_dwordx3 v[88:90], v3, s[16:17] offset:24
    buffer_load_dwordx4 v[8:11], v2, s[8:11], s12 offen nt
    s_add_u32 s12, s12, s6
    buffer_load_dwordx4 v[12:15], v2, s[8:11], s12 offen nt
    s_add_u32 s12, s12, s13
    buffer_load_dwordx4 v[16:19], v2, s[8:11], s12 offen nt
    s_add_u32 s12, s12, s6
    buffer_load_dwordx4 v[20:23], v2, s[8:11], s12 offen nt
    s_add_u32 s12, s12, s13
    buffer_load_dwordx4 v[24:27], v2, s[8:11], s12 offen nt
    s_add_u32 s12, s12, s6
    buffer_load_dwordx4 v[28:31], v2, s[8:11], s12 offen nt
    s_add_u32 s12, s12, s13
    v_and_b32 v6, 1, v0
    v_lshlrev_b32 v6, 4, v6
    v_mov_b32 v7, 0xffff
    v_lshlrev_b32 v7, v6, v7
    v_bfe_u32 v6, v0, 1, 2
    v_cmp_eq_u32 s[46:47], 0, v6
    v_cmp_eq_u32 s[48:49], 1, v6
    v_cmp_eq_u32 s[50:51], 2, v6
    v_cmp_eq_u32 s[52:53], 3, v6
    v_cndmask_b32 v160, 0, v7, s[46:47]
    v_cndmask_b32 v161, 0, v7, s[48:49]
    v_cndmask_b32 v162, 0, v7, s[50:51]
    v_cndmask_b32 v163, 0, v7, s[52:53]
    v_lshlrev_b32 v3, 1, v3
    s_waitcnt vmcnt(6)
    v_lshlrev_b32 v92, 16, v80
    v_and_b32 v93, s43, v80
    v_lshlrev_b32 v94, 16, v81
    v_and_b32 v95, s43, v81
    v_lshlrev_b32 v96, 16, v82
    v_and_b32 v97, s43, v82
    v_lshlrev_b32 v98, 16, v84
    v_and_b32 v99, s43, v84
    v_lshlrev_b32 v100, 16, v85
    v_and_b32 v101, s43, v85
    v_lshlrev_b32 v102, 16, v86
    v_and_b32 v103, s43, v86
    v_lshlrev_b32 v104, 16, v88
    v_and_b32 v105, s43, v88
    v_lshlrev_b32 v106, 16, v89
    v_and_b32 v107, s43, v89
    v_lshlrev_b32 v108, 16, v90
    v_and_b32 v109, s43, v90
    v_pk_add_f32 v[80:81], v[92:93], v[94:95]
    v_pk_add_f32 v[82:83], v[96:97], v[98:99]
    v_pk_add_f32 v[84:85], v[100:101], v[102:103]
    v_pk_add_f32 v[86:87], v[104:105], v[106:107]
    v_pk_add_f32 v[80:81], v[80:81], v[82:83]
    v_pk_add_f32 v[84:85], v[84:85], v[86:87]
    v_pk_add_f32 v[80:81], v[80:81], v[108:109]
    v_pk_add_f32 v[80:81], v[80:81], v[84:85]
    v_add_f32 v80, v80, v81
    s_nop 1
    v_add_f32_dpp v80, v80, v80 quad_perm:[1,0,3,2] row_mask:0xf bank_mask:0xf
    s_nop 1
    v_add_f32_dpp v80, v80, v80 quad_perm:[2,3,0,1] row_mask:0xf bank_mask:0xf
    s_nop 1
    v_add_f32_dpp v80, v80, v80 row_half_mirror row_mask:0xf bank_mask:0xf
    s_nop 1
    v_add_f32_dpp v80, v80, v80 row_mirror row_mask:0xf bank_mask:0xf
    v_mov_b32 v81, v80
    s_nop 1
    v_permlane16_swap_b32 v80, v81
    v_add_f32 v80, v80, v81
    s_mov_b32 s14, 0x3ae38e39
    v_mul_f32 v80, s14, v80
    v_mov_b32 v81, v80
    v_pk_add_f32 v[112:113], v[92:93], v[80:81] neg_lo:[0,1] neg_hi:[0,1]
    v_pk_add_f32 v[114:115], v[94:95], v[80:81] neg_lo:[0,1] neg_hi:[0,1]
    v_pk_add_f32 v[116:117], v[96:97], v[80:81] neg_lo:[0,1] neg_hi:[0,1]
    v_pk_add_f32 v[118:119], v[98:99], v[80:81] neg_lo:[0,1] neg_hi:[0,1]
    v_pk_add_f32 v[120:121], v[100:101], v[80:81] neg_lo:[0,1] neg_hi:[0,1]
    v_pk_add_f32 v[122:123], v[102:103], v[80:81] neg_lo:[0,1] neg_hi:[0,1]
    v_pk_add_f32 v[124:125], v[104:105], v[80:81] neg_lo:[0,1] neg_hi:[0,1]
    v_pk_add_f32 v[126:127], v[106:107], v[80:81] neg_lo:[0,1] neg_hi:[0,1]
    v_pk_add_f32 v[128:129], v[108:109], v[80:81] neg_lo:[0,1] neg_hi:[0,1]
    v_pk_mul_f32 v[84:85], v[112:113], v[112:113]
    v_pk_mul_f32 v[86:87], v[114:115], v[114:115]
    v_pk_fma_f32 v[84:85], v[116:117], v[116:117], v[84:85]
    v_pk_fma_f32 v[86:87], v[118:119], v[118:119], v[86:87]
    v_pk_fma_f32 v[84:85], v[120:121], v[120:121], v[84:85]
    v_pk_fma_f32 v[86:87], v[122:123], v[122:123], v[86:87]
    v_pk_fma_f32 v[84:85], v[124:125], v[124:125], v[84:85]
    v_pk_fma_f32 v[86:87], v[126:127], v[126:127], v[86:87]
    v_pk_fma_f32 v[84:85], v[128:129], v[128:129], v[84:85]
    v_pk_add_f32 v[84:85], v[84:85], v[86:87]
    v_add_f32 v82, v84, v85
    s_nop 1
    v_add_f32_dpp v82, v82, v82 quad_perm:[1,0,3,2] row_mask:0xf bank_mask:0xf
    s_nop 1
    v_add_f32_dpp v82, v82, v82 quad_perm:[2,3,0,1] row_mask:0xf bank_mask:0xf
    s_nop 1
    v_add_f32_dpp v82, v82, v82 row_half_mirror row_mask:0xf bank_mask:0xf
    s_nop 1
    v_add_f32_dpp v82, v82, v82 row_mirror row_mask:0xf bank_mask:0xf
    v_mov_b32 v83, v82
    s_nop 1
    v_permlane16_swap_b32 v82, v83
    v_add_f32 v82, v82, v83
    v_mul_f32 v82, s14, v82
    v_cvt_pk_bf16_f32 v83, v80, v82
    v_lshlrev_b32 v80, 16, v83
    v_and_b32 v82, s43, v83
    v_add_f32 v82, 0x3727c5ac, v82
    v_mov_b32 v81, v80
    v_cvt_pk_bf16_f32 v83, v82, v82
    v_pk_add_f32 v[112:113], v[92:93], v[80:81] neg_lo:[0,1] neg_hi:[0,1]
    v_pk_add_f32 v[114:115], v[94:95], v[80:81] neg_lo:[0,1] neg_hi:[0,1]
    v_pk_add_f32 v[116:117], v[96:97], v[80:81] neg_lo:[0,1] neg_hi:[0,1]
    v_lshlrev_b32 v82, 16, v83
    v_sqrt_f32 v82, v82
    v_pk_add_f32 v[118:119], v[98:99], v[80:81] neg_lo:[0,1] neg_hi:[0,1]
    v_pk_add_f32 v[120:121], v[100:101], v[80:81] neg_lo:[0,1] neg_hi:[0,1]
    v_pk_add_f32 v[122:123], v[102:103], v[80:81] neg_lo:[0,1] neg_hi:[0,1]
    v_cvt_pk_bf16_f32 v83, v82, v82
    v_pk_add_f32 v[124:125], v[104:105], v[80:81] neg_lo:[0,1] neg_hi:[0,1]
    v_pk_add_f32 v[126:127], v[106:107], v[80:81] neg_lo:[0,1] neg_hi:[0,1]
    v_pk_add_f32 v[128:129], v[108:109], v[80:81] neg_lo:[0,1] neg_hi:[0,1]
    v_lshlrev_b32 v82, 16, v83
    v_rcp_f32 v82, v82
    v_cvt_pk_bf16_f32 v92, v112, v113
    v_cvt_pk_bf16_f32 v93, v114, v115
    v_cvt_pk_bf16_f32 v94, v116, v117
    v_cvt_pk_bf16_f32 v95, v118, v119
    v_cvt_pk_bf16_f32 v96, v120, v121
    v_cvt_pk_bf16_f32 v97, v122, v123
    v_cvt_pk_bf16_f32 v98, v124, v125
    v_cvt_pk_bf16_f32 v99, v126, v127
    v_cvt_pk_bf16_f32 v100, v128, v129
    v_mov_b32 v83, v82
    v_lshlrev_b32 v112, 16, v92
    v_and_b32 v113, s43, v92
    v_lshlrev_b32 v114, 16, v93
    v_and_b32 v115, s43, v93
    v_lshlrev_b32 v116, 16, v94
    v_and_b32 v117, s43, v94
    v_lshlrev_b32 v118, 16, v95
    v_and_b32 v119, s43, v95
    v_lshlrev_b32 v120, 16, v96
    v_and_b32 v121, s43, v96
    v_lshlrev_b32 v122, 16, v97
    v_and_b32 v123, s43, v97
    v_lshlrev_b32 v124, 16, v98
    v_and_b32 v125, s43, v98
    v_lshlrev_b32 v126, 16, v99
    v_and_b32 v127, s43, v99
    v_lshlrev_b32 v128, 16, v100
    v_and_b32 v129, s43, v100
    v_pk_mul_f32 v[112:113], v[112:113], v[82:83]
    v_pk_mul_f32 v[114:115], v[114:115], v[82:83]
    v_pk_mul_f32 v[116:117], v[116:117], v[82:83]
    v_pk_mul_f32 v[118:119], v[118:119], v[82:83]
    v_pk_mul_f32 v[120:121], v[120:121], v[82:83]
    v_pk_mul_f32 v[122:123], v[122:123], v[82:83]
    v_pk_mul_f32 v[124:125], v[124:125], v[82:83]
    v_pk_mul_f32 v[126:127], v[126:127], v[82:83]
    v_pk_mul_f32 v[128:129], v[128:129], v[82:83]
    v_cvt_pk_bf16_f32 v112, v112, v112
    v_cvt_pk_bf16_f32 v113, v113, v113
    ds_write_b64 v3, v[112:113] offset:0
    v_cvt_pk_bf16_f32 v114, v114, v114
    v_cvt_pk_bf16_f32 v115, v115, v115
    ds_write_b64 v3, v[114:115] offset:8
    v_cvt_pk_bf16_f32 v116, v116, v116
    v_cvt_pk_bf16_f32 v117, v117, v117
    ds_write_b64 v3, v[116:117] offset:16
    v_cvt_pk_bf16_f32 v118, v118, v118
    v_cvt_pk_bf16_f32 v119, v119, v119
    ds_write_b64 v3, v[118:119] offset:24
    v_cvt_pk_bf16_f32 v120, v120, v120
    v_cvt_pk_bf16_f32 v121, v121, v121
    ds_write_b64 v3, v[120:121] offset:32
    v_cvt_pk_bf16_f32 v122, v122, v122
    v_cvt_pk_bf16_f32 v123, v123, v123
    ds_write_b64 v3, v[122:123] offset:40
    v_cvt_pk_bf16_f32 v124, v124, v124
    v_cvt_pk_bf16_f32 v125, v125, v125
    ds_write_b64 v3, v[124:125] offset:48
    v_cvt_pk_bf16_f32 v126, v126, v126
    v_cvt_pk_bf16_f32 v127, v127, v127
    ds_write_b64 v3, v[126:127] offset:56
    v_cvt_pk_bf16_f32 v128, v128, v128
    v_cvt_pk_bf16_f32 v129, v129, v129
    ds_write_b64 v3, v[128:129] offset:64
    v_bfe_u32 v3, v0, 3, 1
    v_mul_u32_u24 v3, 2304, v3
    v_lshrrev_b32 v4, 4, v0
    v_lshl_add_u32 v3, v4, 3, v3
    s_lshl_b32 s15, s15, 2
    v_add_u32 v3, s15, v3
    ds_read_b64 v[92:93], v3 offset:0
    ds_read_b64 v[94:95], v3 offset:32
    ds_read_b64 v[96:97], v3 offset:64
    ds_read_b64 v[98:99], v3 offset:96
    ds_read_b64 v[100:101], v3 offset:128
    ds_read_b64 v[102:103], v3 offset:160
    ds_read_b64 v[104:105], v3 offset:192
    ds_read_b64 v[106:107], v3 offset:224
    s_lshl_b32 s4, s3, 10
    v_lshl_add_u32 v4, v0, 4, s4
    s_waitcnt lgkmcnt(0)
    s_add_u32 s40, s40, 1
    s_movk_i32 s41, 0x3ff
    s_and_b32 s42, s40, s41
    v_mov_b32 v150, s42
    v_and_b32 v149, 63, v150
    v_and_b32 v132, v92, v160
    v_and_b32 v133, v92, v161
    v_and_b32 v134, v92, v162
    v_and_b32 v135, v92, v163
    v_and_b32 v136, v93, v160
    v_and_b32 v137, v93, v161
    v_and_b32 v138, v93, v162
    v_and_b32 v139, v93, v163
    s_waitcnt vmcnt(5)
    v_mfma_f32_16x16x32_bf16 v[140:143], v[132:135], v[8:11], 0
    buffer_load_dwordx4 v[32:35], v2, s[8:11], s12 offen nt
    s_add_u32 s12, s12, s6
    v_and_b32 v132, v94, v160
    v_and_b32 v133, v94, v161
    v_and_b32 v134, v94, v162
    v_and_b32 v135, v94, v163
    s_waitcnt vmcnt(5)
    v_mfma_f32_16x16x32_bf16 v[140:143], v[136:139], v[12:15], v[140:143]
    buffer_load_dwordx4 v[36:39], v2, s[8:11], s12 offen nt
    s_add_u32 s12, s12, s13
    v_and_b32 v136, v95, v160
    v_and_b32 v137, v95, v161
    v_and_b32 v138, v95, v162
    v_and_b32 v139, v95, v163
    s_waitcnt vmcnt(5)
    v_mfma_f32_16x16x32_bf16 v[140:143], v[132:135], v[16:19], v[140:143]
    buffer_load_dwordx4 v[40:43], v2, s[8:11], s12 offen nt
    s_add_u32 s12, s12, s6
    v_and_b32 v132, v96, v160
    v_and_b32 v133, v96, v161
    v_and_b32 v134, v96, v162
    v_and_b32 v135, v96, v163
    s_waitcnt vmcnt(5)
    v_mfma_f32_16x16x32_bf16 v[140:143], v[136:139], v[20:23], v[140:143]
    buffer_load_dwordx4 v[44:47], v2, s[8:11], s12 offen nt
    s_add_u32 s12, s12, s13
    v_and_b32 v136, v97, v160
    v_and_b32 v137, v97, v161
    v_and_b32 v138, v97, v162
    v_and_b32 v139, v97, v163
    s_waitcnt vmcnt(5)
    v_mfma_f32_16x16x32_bf16 v[140:143], v[132:135], v[24:27], v[140:143]
    buffer_load_dwordx4 v[48:51], v2, s[8:11], s12 offen nt
    s_add_u32 s12, s12, s6
    v_and_b32 v132, v98, v160
    v_and_b32 v133, v98, v161
    v_and_b32 v134, v98, v162
    v_and_b32 v135, v98, v163
    s_waitcnt vmcnt(5)
    v_mfma_f32_16x16x32_bf16 v[140:143], v[136:139], v[28:31], v[140:143]
    buffer_load_dwordx4 v[52:55], v2, s[8:11], s12 offen nt
    s_add_u32 s12, s12, s13
    v_and_b32 v136, v99, v160
    v_and_b32 v137, v99, v161
    v_and_b32 v138, v99, v162
    v_and_b32 v139, v99, v163
    s_waitcnt vmcnt(5)
    v_mfma_f32_16x16x32_bf16 v[140:143], v[132:135], v[32:35], v[140:143]
    buffer_load_dwordx4 v[56:59], v2, s[8:11], s12 offen nt
    s_add_u32 s12, s12, s6
    v_and_b32 v132, v100, v160
    v_and_b32 v133, v100, v161
    v_and_b32 v134, v100, v162
    v_and_b32 v135, v100, v163
    s_waitcnt vmcnt(5)
    v_mfma_f32_16x16x32_bf16 v[140:143], v[136:139], v[36:39], v[140:143]
    buffer_load_dwordx4 v[60:63], v2, s[8:11], s12 offen nt
    s_add_u32 s12, s12, s13
    v_and_b32 v136, v101, v160
    v_and_b32 v137, v101, v161
    v_and_b32 v138, v101, v162
    v_and_b32 v139, v101, v163
    s_waitcnt vmcnt(5)
    v_mfma_f32_16x16x32_bf16 v[140:143], v[132:135], v[40:43], v[140:143]
    buffer_load_dwordx4 v[64:67], v2, s[8:11], s12 offen nt
    s_add_u32 s12, s12, s6
    v_and_b32 v132, v102, v160
    v_and_b32 v133, v102, v161
    v_and_b32 v134, v102, v162
    v_and_b32 v135, v102, v163
    s_waitcnt vmcnt(5)
    v_mfma_f32_16x16x32_bf16 v[140:143], v[136:139], v[44:47], v[140:143]
    buffer_load_dwordx4 v[68:71], v2, s[8:11], s12 offen nt
    v_and_b32 v136, v103, v160
    v_and_b32 v137, v103, v161
    v_and_b32 v138, v103, v162
    v_and_b32 v139, v103, v163
    s_waitcnt vmcnt(5)
    v_mfma_f32_16x16x32_bf16 v[140:143], v[132:135], v[48:51], v[140:143]
    v_and_b32 v132, v104, v160
    v_and_b32 v133, v104, v161
    v_and_b32 v134, v104, v162
    v_and_b32 v135, v104, v163
    s_waitcnt vmcnt(4)
    v_mfma_f32_16x16x32_bf16 v[140:143], v[136:139], v[52:55], v[140:143]
    v_and_b32 v136, v105, v160
    v_and_b32 v137, v105, v161
    v_and_b32 v138, v105, v162
    v_and_b32 v139, v105, v163
    s_waitcnt vmcnt(3)
    v_mfma_f32_16x16x32_bf16 v[140:143], v[132:135], v[56:59], v[140:143]
    v_and_b32 v132, v106, v160
    v_and_b32 v133, v106, v161
    v_and_b32 v134, v106, v162
    v_and_b32 v135, v106, v163
    s_waitcnt vmcnt(2)
    v_mfma_f32_16x16x32_bf16 v[140:143], v[136:139], v[60:63], v[140:143]
    v_and_b32 v136, v107, v160
    v_and_b32 v137, v107, v161
    v_and_b32 v138, v107, v162
    v_and_b32 v139, v107, v163
    s_waitcnt vmcnt(1)
    v_mfma_f32_16x16x32_bf16 v[140:143], v[132:135], v[64:67], v[140:143]
    s_waitcnt vmcnt(0)
    v_mfma_f32_16x16x32_bf16 v[140:143], v[136:139], v[68:71], v[140:143]
    s_nop 7
    ds_write_b128 v4, v[140:143] offset:14336
    v_mov_b32 v5, 1
    s_mov_b64 exec, 1
    ds_add_u32 v1, v5 offset:5384
    s_mov_b64 exec, -1
    s_min_u32 s4, s3, s5
    s_cmp_lg_u32 s4, 0
    s_cbranch_scc1 L_s1done
    s_mul_i32 s4, s65, 26624
    s_lshl_b32 s7, s7, 7
    s_add_u32 s4, s4, s7
    s_lshl_b32 s4, s4, 2
    s_add_u32 s12, s4, 65536
    v_lshrrev_b32 v3, 5, v0
    v_mul_u32_u24 v3, 53248, v3
    v_and_b32 v4, 15, v0
    v_lshl_add_u32 v3, v4, 5, v3
    v_bfe_u32 v4, v0, 4, 1
    v_lshl_add_u32 v3, v4, 4, v3
    s_sub_u32 s5, s5, s3
    s_add_u32 s4, s5, 0
    s_cmp_lt_u32 s4, 9
    s_cselect_b32 s46, 1.0, 0
    s_add_u32 s4, s5, 1
    s_cmp_lt_u32 s4, 9
    s_cselect_b32 s47, 1.0, 0
    s_add_u32 s4, s5, 2
    s_cmp_lt_u32 s4, 9
    s_cselect_b32 s48, 1.0, 0
    s_add_u32 s4, s5, 3
    s_cmp_lt_u32 s4, 9
    s_cselect_b32 s49, 1.0, 0
    v_lshlrev_b32 v4, 4, v0
L_ws1:
    ds_read_b32 v5, v1 offset:5384
    s_waitcnt lgkmcnt(0)
    v_readfirstlane_b32 s59, v5
    s_nop 0
    s_cmp_ge_u32 s59, 4
    s_cbranch_scc1 L_ws1_ok
    s_sleep 1
    s_branch L_ws1
L_ws1_ok:
    ds_read_b128 v[64:67], v4 offset:14336
    ds_read_b128 v[68:71], v4 offset:15360
    ds_read_b128 v[72:75], v4 offset:16384
    ds_read_b128 v[76:79], v4 offset:17408
    s_waitcnt lgkmcnt(0)
    v_mul_f32 v64, s46, v64
    v_mul_f32 v65, s46, v65
    v_mul_f32 v66, s46, v66
    v_mul_f32 v67, s46, v67
    v_fmac_f32 v64, s47, v68
    v_fmac_f32 v65, s47, v69
    v_fmac_f32 v66, s47, v70
    v_fmac_f32 v67, s47, v71
    v_fmac_f32 v64, s48, v72
    v_fmac_f32 v65, s48, v73
    v_fmac_f32 v66, s48, v74
    v_fmac_f32 v67, s48, v75
    v_fmac_f32 v64, s49, v76
    v_fmac_f32 v65, s49, v77
    v_fmac_f32 v66, s49, v78
    v_fmac_f32 v67, s49, v79
    v_add_u32 v64, 32, v64
    v_add_u32 v65, 32, v65
    v_add_u32 v66, 32, v66
    v_add_u32 v67, 32, v67
    v_bfi_b32 v64, 63, v150, v64
    v_bfi_b32 v65, 63, v150, v65
    v_bfi_b32 v66, 63, v150, v66
    v_bfi_b32 v67, 63, v150, v67
    buffer_store_dwordx4 v[64:67], v3, s[60:63], s12 offen sc1
    s_branch L_s1done
L_nos1:
    v_mov_b32 v1, 0
    v_mov_b32 v138, 0
    v_mov_b32 v139, 0
    s_lshl_b32 s58, s3, 9
    v_lshl_add_u32 v136, v0, 3, s58
    ds_write_b64 v136, v[138:139] offset:5120
    s_mov_b32 s43, 0xffff0000
    s_mov_b32 s60, s38
    s_mov_b32 s61, s39
    s_mov_b32 s62, 2097152
    s_mov_b32 s63, s11
    s_waitcnt lgkmcnt(0)
    s_load_dword s40, s[38:39], 0
    s_barrier
    v_mov_b32 v140, 0
    v_mov_b32 v141, 0
    v_mov_b32 v142, 0
    v_mov_b32 v143, 0
    v_lshlrev_b32 v4, 4, v0
    ds_write_b128 v4, v[140:143] offset:17408
    v_and_b32 v6, 1, v0
    v_lshlrev_b32 v6, 4, v6
    v_mov_b32 v7, 0xffff
    v_lshlrev_b32 v7, v6, v7
    v_bfe_u32 v6, v0, 1, 2
    v_cmp_eq_u32 s[46:47], 0, v6
    v_cmp_eq_u32 s[48:49], 1, v6
    v_cmp_eq_u32 s[50:51], 2, v6
    v_cmp_eq_u32 s[52:53], 3, v6
    v_cndmask_b32 v160, 0, v7, s[46:47]
    v_cndmask_b32 v161, 0, v7, s[48:49]
    v_cndmask_b32 v162, 0, v7, s[50:51]
    v_cndmask_b32 v163, 0, v7, s[52:53]
    s_waitcnt lgkmcnt(0)
    s_add_u32 s40, s40, 1
    s_movk_i32 s41, 0x3ff
    s_and_b32 s42, s40, s41
    v_mov_b32 v150, s42
    v_and_b32 v149, 63, v150
    v_mov_b32 v5, 1
    s_mov_b64 exec, 1
    ds_add_u32 v1, v5 offset:5384
    s_mov_b64 exec, -1
L_s1done:
    s_cmp_lg_u32 s3, 0
    s_cbranch_scc1 L_noq
    s_lshr_b32 s5, s55, 3
    s_mul_i32 s5, s5, 53248
    s_lshl_b32 s4, s54, 10
    s_add_u32 s4, s4, s5
    s_add_u32 s12, s4, 65536
    s_add_u32 s13, s12, 106496
    s_add_u32 s15, s12, 212992
    v_lshlrev_b32 v4, 4, v0
    v_lshlrev_b32 v3, 3, v0
    s_mov_b32 s14, 30015
L_wcp:
    ds_read_b32 v26, v1 offset:5400
    s_waitcnt lgkmcnt(0)
    v_readfirstlane_b32 s59, v26
    s_nop 0
    s_cmp_ge_u32 s59, 4
    s_cbranch_scc1 L_wcp_ok
    s_sleep 4
    s_branch L_wcp
L_wcp_ok:
L_qloop:
    buffer_load_dwordx4 v[24:27], v4, s[60:63], s12 offen sc1
    buffer_load_dwordx4 v[28:31], v4, s[60:63], s13 offen sc1
    buffer_load_dwordx4 v[32:35], v4, s[60:63], s15 offen sc1
    s_sub_u32 s14, s14, 1
    s_cbranch_scc1 L_qok
    s_waitcnt vmcnt(0)
    v_xor_b32 v24, v149, v24
    v_xor_b32 v25, v149, v25
    v_xor_b32 v26, v149, v26
    v_xor_b32 v27, v149, v27
    v_xor_b32 v28, v149, v28
    v_xor_b32 v29, v149, v29
    v_xor_b32 v30, v149, v30
    v_xor_b32 v31, v149, v31
    v_xor_b32 v32, v149, v32
    v_xor_b32 v33, v149, v33
    v_xor_b32 v34, v149, v34
    v_xor_b32 v35, v149, v35
    v_or3_b32 v36, v24, v25, v26
    v_or3_b32 v37, v27, v28, v29
    v_or3_b32 v38, v30, v31, v32
    v_or3_b32 v39, v33, v34, v35
    v_or3_b32 v40, v36, v37, v38
    v_or_b32 v41, v39, v40
    v_and_b32 v42, 63, v41
    v_cmp_ne_u32 vcc, 0, v42
    s_cbranch_vccnz L_qloop
L_qok:
    s_waitcnt vmcnt(0)
    v_add_f32 v24, v24, v28
    v_add_f32 v25, v25, v29
    v_add_f32 v26, v26, v30
    v_add_f32 v27, v27, v31
    v_add_f32 v24, v24, v32
    v_add_f32 v25, v25, v33
    v_add_f32 v26, v26, v34
    v_add_f32 v27, v27, v35
    v_cvt_pk_bf16_f32 v24, v24, v25
    v_cvt_pk_bf16_f32 v25, v26, v27
L_wcs1:
    ds_read_b32 v26, v1 offset:5384
    s_waitcnt lgkmcnt(0)
    v_readfirstlane_b32 s59, v26
    s_nop 0
    s_cmp_ge_u32 s59, 4
    s_cbranch_scc1 L_wcs1_ok
    s_sleep 1
    s_branch L_wcs1
L_wcs1_ok:
    v_mov_b32 v26, 1
    ds_write_b64 v3, v[24:25] offset:4608
    ds_write_b32 v1, v26 offset:5388
L_noq:
    v_and_b32 v6, 15, v0
    v_lshrrev_b32 v7, 4, v0
    s_mul_i32 s46, s3, 768
    s_and_b32 s4, s2, 7
    s_lshr_b32 s5, s2, 3
    s_cmp_ge_u32 s2, 144
    s_cbranch_scc1 L_w2dec
    s_lshl_b32 s4, s4, 1
    s_cmp_ge_u32 s5, 9
    s_cselect_b32 s6, 9, 0
    s_addc_u32 s47, s4, 0
    s_sub_u32 s48, s5, s6
    s_lshl2_add_u32 s15, s47, s3
    s_mul_i32 s12, s15, 73728
    s_mov_b32 s8, s24
    s_mov_b32 s9, s25
    s_mov_b32 s10, 4718592
    s_branch L_fdec
L_w2dec:
    s_sub_u32 s48, s5, 18
    s_mov_b32 s6, s4
    s_cmp_lt_u32 s48, 9
    s_cbranch_scc1 L_w2a
    s_lshr_b32 s6, s4, 1
    s_add_u32 s6, s6, 8
    s_and_b32 s4, s4, 1
    s_mul_i32 s4, s4, 5
    s_add_u32 s48, s48, s4
    s_sub_u32 s48, s48, 9
    s_cmp_ge_u32 s48, 9
    s_cbranch_scc1 L_auxend
L_w2a:
    s_add_u32 s47, s6, 16
    s_lshl2_add_u32 s15, s6, s3
    s_mul_i32 s12, s15, 110592
    s_mov_b32 s8, s32
    s_mov_b32 s9, s33
    s_mov_b32 s10, 5308416
L_fdec:
    s_lshl_b32 s5, s48, 7
    s_add_u32 s12, s12, s5
    s_add_u32 s13, s12, 36864
    s_add_u32 s14, s12, 73728
    v_lshrrev_b32 v2, 3, v0
    v_mul_u32_u24 v2, 4608, v2
    v_and_b32 v3, 7, v0
    v_lshl_add_u32 v2, v3, 4, v2
    s_lshl_b32 s4, s48, 13
    s_lshl_b32 s5, s47, 7
    s_add_u32 s4, s4, s5
    s_add_u32 s57, s4, 655360
    v_lshrrev_b32 v4, 5, v0
    v_mul_u32_u24 v101, 18, v4
    v_bfe_u32 v5, v0, 2, 1
    v_add_lshl_u32 v101, v101, v5, 12
    v_and_b32 v5, 3, v0
    v_lshl_add_u32 v101, v5, 5, v101
    v_and_b32 v3, 1, v7
    v_lshl_add_u32 v101, v3, 4, v101
    v_bfe_u32 v5, v0, 3, 1
    v_mul_u32_u24 v106, 384, v5
    v_lshl_add_u32 v106, v7, 5, v106
    v_add_u32 v106, s46, v106
    s_lshl_b32 s4, s3, 10
    v_lshl_add_u32 v107, v0, 4, s4
    v_lshlrev_b32 v103, 4, v0
    v_mul_u32_u24 v100, 384, v4
    v_add_u32 v100, s46, v100
    s_mov_b64 exec, 1
    buffer_load_dword v59, v2, s[8:11], s12 offen nt
    global_load_dword v58, v1, s[34:35]
    s_mov_b64 exec, -1
    s_cmp_ge_u32 s2, 144
    s_cbranch_scc1 L_w2ld
    s_lshl_b32 s4, s15, 12
    s_add_u32 s4, s4, 393216
    v_lshl_add_u32 v104, v0, 4, s4
    s_lshr_b32 s4, s15, 1
    s_lshl_b32 s4, s4, 8
    s_add_u32 s4, s4, 4096
    v_add_u32 v105, v0, v7
    v_and_b32 v105, 7, v105
    v_and_or_b32 v105, v0, 8, v105
    v_lshl_add_u32 v105, v105, 4, s4
    v_lshl_add_u32 v100, v6, 4, v100
    v_lshl_add_u32 v100, v3, 3, v100
L_tro:
    ds_read_b32 v5, v1 offset:5376
    s_waitcnt lgkmcnt(0)
    v_readfirstlane_b32 s59, v5
    s_nop 0
    s_cmp_ge_u32 s59, 8
    s_cbranch_scc1 L_tro_ok
    s_sleep 2
    s_branch L_tro
L_tro_ok:
    buffer_load_dwordx4 v[8:11], v2, s[8:11], s12 offen offset:0 nt
    buffer_load_dwordx4 v[12:15], v2, s[8:11], s12 offen offset:1152 nt
    buffer_load_dwordx4 v[16:19], v2, s[8:11], s12 offen offset:2304 nt
    buffer_load_dwordx4 v[20:23], v2, s[8:11], s12 offen offset:3456 nt
    buffer_load_dwordx4 v[24:27], v2, s[8:11], s13 offen offset:0 nt
    buffer_load_dwordx4 v[28:31], v2, s[8:11], s13 offen offset:1152 nt
    buffer_load_dwordx4 v[32:35], v2, s[8:11], s13 offen offset:2304 nt
    buffer_load_dwordx4 v[36:39], v2, s[8:11], s13 offen offset:3456 nt
    s_mov_b32 s14, 30015
L_wpub:
    ds_read_b32 v5, v1 offset:5380
    s_waitcnt lgkmcnt(0)
    v_readfirstlane_b32 s59, v5
    s_nop 0
    s_cmp_ge_u32 s59, 9
    s_cbranch_scc1 L_wpub_ok
    s_sleep 1
    s_branch L_wpub
L_wpub_ok:
L_h2loop:
    s_and_b32 s4, s14, 63
    s_cselect_b32 s56, 1048576, 0
    buffer_load_dwordx4 v[76:79], v105, s[60:63], s56 offen sc1
    buffer_load_dwordx4 v[80:83], v104, s[60:63], s56 offen offset:0 sc1
    buffer_load_dwordx4 v[84:87], v104, s[60:63], s56 offen offset:1024 sc1
    buffer_load_dwordx4 v[88:91], v104, s[60:63], s56 offen offset:2048 sc1
    buffer_load_dwordx4 v[92:95], v104, s[60:63], s56 offen offset:3072 sc1
    s_sub_u32 s14, s14, 1
    s_cbranch_scc1 L_h2ok
    s_waitcnt vmcnt(0)
    v_xor_b32 v76, v150, v76
    v_xor_b32 v77, v150, v77
    v_xor_b32 v78, v150, v78
    v_xor_b32 v79, v150, v79
    v_xor_b32 v80, v150, v80
    v_xor_b32 v81, v150, v81
    v_xor_b32 v82, v150, v82
    v_xor_b32 v83, v150, v83
    v_xor_b32 v84, v150, v84
    v_xor_b32 v85, v150, v85
    v_xor_b32 v86, v150, v86
    v_xor_b32 v87, v150, v87
    v_xor_b32 v88, v150, v88
    v_xor_b32 v89, v150, v89
    v_xor_b32 v90, v150, v90
    v_xor_b32 v91, v150, v91
    v_xor_b32 v92, v150, v92
    v_xor_b32 v93, v150, v93
    v_xor_b32 v94, v150, v94
    v_xor_b32 v95, v150, v95
    v_or3_b32 v60, v76, v77, v78
    v_or3_b32 v61, v79, v80, v81
    v_or3_b32 v62, v82, v83, v84
    v_or3_b32 v63, v85, v86, v87
    v_or3_b32 v64, v88, v89, v90
    v_or3_b32 v65, v91, v92, v93
    v_or3_b32 v66, v94, v95, v60
    v_or3_b32 v67, v61, v62, v63
    v_or3_b32 v68, v64, v65, v66
    v_or_b32 v69, v67, v68
    v_and_b32 v70, s41, v69
    v_cmp_ne_u32 vcc, 0, v70
    s_cbranch_vccnz L_h2loop
L_h2ok:
    s_waitcnt vmcnt(0)
    v_max_f32_dpp v78, v78, v78 quad_perm:[1,0,3,2] row_mask:0xf bank_mask:0xf
    s_nop 1
    v_max_f32_dpp v78, v78, v78 quad_perm:[2,3,0,1] row_mask:0xf bank_mask:0xf
    s_nop 1
    v_max_f32_dpp v78, v78, v78 row_half_mirror row_mask:0xf bank_mask:0xf
    v_sub_f32 v76, v76, v78
    v_exp_f32 v76, v76
    s_nop 0
    v_mul_f32 v77, v76, v77
    v_mul_f32_dpp v80, v76, v80 row_newbcast:0 row_mask:0xf bank_mask:0xf
    v_mul_f32_dpp v81, v76, v81 row_newbcast:0 row_mask:0xf bank_mask:0xf
    v_mul_f32_dpp v82, v76, v82 row_newbcast:0 row_mask:0xf bank_mask:0xf
    v_mul_f32_dpp v83, v76, v83 row_newbcast:0 row_mask:0xf bank_mask:0xf
    v_mul_f32_dpp v88, v76, v88 row_newbcast:8 row_mask:0xf bank_mask:0xf
    v_mul_f32_dpp v89, v76, v89 row_newbcast:8 row_mask:0xf bank_mask:0xf
    v_mul_f32_dpp v90, v76, v90 row_newbcast:8 row_mask:0xf bank_mask:0xf
    v_mul_f32_dpp v91, v76, v91 row_newbcast:8 row_mask:0xf bank_mask:0xf
    v_add_f32_dpp v77, v77, v77 quad_perm:[1,0,3,2] row_mask:0xf bank_mask:0xf
    v_fmac_f32_dpp v80, v76, v84 row_newbcast:4 row_mask:0xf bank_mask:0xf
    v_fmac_f32_dpp v81, v76, v85 row_newbcast:4 row_mask:0xf bank_mask:0xf
    v_fmac_f32_dpp v82, v76, v86 row_newbcast:4 row_mask:0xf bank_mask:0xf
    v_fmac_f32_dpp v83, v76, v87 row_newbcast:4 row_mask:0xf bank_mask:0xf
    v_add_f32_dpp v77, v77, v77 quad_perm:[2,3,0,1] row_mask:0xf bank_mask:0xf
    v_fmac_f32_dpp v88, v76, v92 row_newbcast:12 row_mask:0xf bank_mask:0xf
    v_fmac_f32_dpp v89, v76, v93 row_newbcast:12 row_mask:0xf bank_mask:0xf
    v_fmac_f32_dpp v90, v76, v94 row_newbcast:12 row_mask:0xf bank_mask:0xf
    v_fmac_f32_dpp v91, v76, v95 row_newbcast:12 row_mask:0xf bank_mask:0xf
    v_add_f32_dpp v77, v77, v77 row_half_mirror row_mask:0xf bank_mask:0xf
    v_permlane32_swap_b32 v80, v88
    v_permlane32_swap_b32 v81, v89
    v_permlane32_swap_b32 v82, v90
    v_permlane32_swap_b32 v83, v91
    v_rcp_f32 v77, v77
    v_add_f32 v80, v80, v88
    v_add_f32 v81, v81, v89
    v_add_f32 v82, v82, v90
    v_add_f32 v83, v83, v91
    v_mov_b32_dpp v78, v77 row_newbcast:0 row_mask:0xf bank_mask:0xf
    s_nop 1
    v_mov_b32_dpp v78, v77 row_newbcast:8 row_mask:0xc bank_mask:0xf
    v_permlane16_swap_b32 v80, v82
    v_permlane16_swap_b32 v81, v83
    v_add_f32 v80, v80, v82
    v_add_f32 v81, v81, v83
    v_mul_f32 v80, v80, v78
    v_mul_f32 v81, v81, v78
    v_cvt_pk_bf16_f32 v80, v80, v80
    v_cvt_pk_bf16_f32 v81, v81, v81
    ds_write_b64 v100, v[80:81] offset:11264
    ds_read_b128 v[108:111], v106 offset:11264
    ds_read_b128 v[112:115], v106 offset:11280
    ds_read_b128 v[116:119], v106 offset:11392
    ds_read_b128 v[120:123], v106 offset:11408
    s_waitcnt lgkmcnt(2)
    v_and_b32 v60, v108, v160
    v_and_b32 v61, v108, v161
    v_and_b32 v62, v108, v162
    v_and_b32 v63, v108, v163
    v_and_b32 v64, v112, v160
    v_and_b32 v65, v112, v161
    v_and_b32 v66, v112, v162
    v_and_b32 v67, v112, v163
    v_and_b32 v68, v109, v160
    v_and_b32 v69, v109, v161
    v_and_b32 v70, v109, v162
    v_and_b32 v71, v109, v163
    v_and_b32 v72, v113, v160
    v_and_b32 v73, v113, v161
    v_and_b32 v74, v113, v162
    v_and_b32 v75, v113, v163
    v_mfma_f32_16x16x32_bf16 v[140:143], v[60:63], v[8:11], 0
    v_mfma_f32_16x16x32_bf16 v[144:147], v[64:67], v[8:11], 0
    v_and_b32 v60, v110, v160
    v_and_b32 v61, v110, v161
    v_and_b32 v62, v110, v162
    v_and_b32 v63, v110, v163
    v_and_b32 v64, v114, v160
    v_and_b32 v65, v114, v161
    v_and_b32 v66, v114, v162
    v_and_b32 v67, v114, v163
    v_mfma_f32_16x16x32_bf16 v[140:143], v[68:71], v[12:15], v[140:143]
    v_mfma_f32_16x16x32_bf16 v[144:147], v[72:75], v[12:15], v[144:147]
    v_and_b32 v68, v111, v160
    v_and_b32 v69, v111, v161
    v_and_b32 v70, v111, v162
    v_and_b32 v71, v111, v163
    v_and_b32 v72, v115, v160
    v_and_b32 v73, v115, v161
    v_and_b32 v74, v115, v162
    v_and_b32 v75, v115, v163
    v_mfma_f32_16x16x32_bf16 v[140:143], v[60:63], v[16:19], v[140:143]
    v_mfma_f32_16x16x32_bf16 v[144:147], v[64:67], v[16:19], v[144:147]
    s_waitcnt lgkmcnt(0)
    v_and_b32 v60, v116, v160
    v_and_b32 v61, v116, v161
    v_and_b32 v62, v116, v162
    v_and_b32 v63, v116, v163
    v_and_b32 v64, v120, v160
    v_and_b32 v65, v120, v161
    v_and_b32 v66, v120, v162
    v_and_b32 v67, v120, v163
    v_mfma_f32_16x16x32_bf16 v[140:143], v[68:71], v[20:23], v[140:143]
    v_mfma_f32_16x16x32_bf16 v[144:147], v[72:75], v[20:23], v[144:147]
    v_and_b32 v68, v117, v160
    v_and_b32 v69, v117, v161
    v_and_b32 v70, v117, v162
    v_and_b32 v71, v117, v163
    v_and_b32 v72, v121, v160
    v_and_b32 v73, v121, v161
    v_and_b32 v74, v121, v162
    v_and_b32 v75, v121, v163
    v_mfma_f32_16x16x32_bf16 v[140:143], v[60:63], v[24:27], v[140:143]
    v_mfma_f32_16x16x32_bf16 v[144:147], v[64:67], v[24:27], v[144:147]
    v_and_b32 v60, v118, v160
    v_and_b32 v61, v118, v161
    v_and_b32 v62, v118, v162
    v_and_b32 v63, v118, v163
    v_and_b32 v64, v122, v160
    v_and_b32 v65, v122, v161
    v_and_b32 v66, v122, v162
    v_and_b32 v67, v122, v163
    v_mfma_f32_16x16x32_bf16 v[140:143], v[68:71], v[28:31], v[140:143]
    v_mfma_f32_16x16x32_bf16 v[144:147], v[72:75], v[28:31], v[144:147]
    v_and_b32 v68, v119, v160
    v_and_b32 v69, v119, v161
    v_and_b32 v70, v119, v162
    v_and_b32 v71, v119, v163
    v_and_b32 v72, v123, v160
    v_and_b32 v73, v123, v161
    v_and_b32 v74, v123, v162
    v_and_b32 v75, v123, v163
    v_mfma_f32_16x16x32_bf16 v[140:143], v[60:63], v[32:35], v[140:143]
    v_mfma_f32_16x16x32_bf16 v[144:147], v[64:67], v[32:35], v[144:147]
    v_mfma_f32_16x16x32_bf16 v[140:143], v[68:71], v[36:39], v[140:143]
    v_mfma_f32_16x16x32_bf16 v[144:147], v[72:75], v[36:39], v[144:147]
    s_branch L_fred
L_w2ld:
    v_and_b32 v3, 31, v0
    v_lshl_add_u32 v100, v3, 4, v100
    s_mul_i32 s5, s15, 384
    s_mov_b32 s15, 30015
    s_add_u32 s48, s5, 81920
    s_add_u32 s49, s48, 106496
    s_add_u32 s50, s48, 212992
    s_add_u32 s51, s48, 18432
    s_add_u32 s52, s48, 124928
    s_add_u32 s53, s48, 231424
    v_mul_u32_u24 v102, 53248, v4
    v_lshl_add_u32 v102, v3, 4, v102
L_trg:
    ds_read_b32 v5, v1 offset:5400
    s_waitcnt lgkmcnt(0)
    v_readfirstlane_b32 s59, v5
    s_nop 0
    s_cmp_ge_u32 s59, 4
    s_cbranch_scc1 L_trg_ok
    s_sleep 4
    s_branch L_trg
L_trg_ok:
    s_mov_b32 exec_lo, 0x00ffffff
    s_mov_b32 exec_hi, 0x00ffffff
L_guloop:
    buffer_load_dwordx4 v[76:79], v102, s[60:63], s48 offen sc1
    buffer_load_dwordx4 v[80:83], v102, s[60:63], s49 offen sc1
    buffer_load_dwordx4 v[84:87], v102, s[60:63], s50 offen sc1
    buffer_load_dwordx4 v[88:91], v102, s[60:63], s51 offen sc1
    buffer_load_dwordx4 v[92:95], v102, s[60:63], s52 offen sc1
    buffer_load_dwordx4 v[96:99], v102, s[60:63], s53 offen sc1
    s_sub_u32 s15, s15, 1
    s_cbranch_scc1 L_guok
    s_waitcnt vmcnt(0)
    v_xor_b32 v76, v149, v76
    v_xor_b32 v77, v149, v77
    v_xor_b32 v78, v149, v78
    v_xor_b32 v79, v149, v79
    v_xor_b32 v80, v149, v80
    v_xor_b32 v81, v149, v81
    v_xor_b32 v82, v149, v82
    v_xor_b32 v83, v149, v83
    v_xor_b32 v84, v149, v84
    v_xor_b32 v85, v149, v85
    v_xor_b32 v86, v149, v86
    v_xor_b32 v87, v149, v87
    v_xor_b32 v88, v149, v88
    v_xor_b32 v89, v149, v89
    v_xor_b32 v90, v149, v90
    v_xor_b32 v91, v149, v91
    v_xor_b32 v92, v149, v92
    v_xor_b32 v93, v149, v93
    v_xor_b32 v94, v149, v94
    v_xor_b32 v95, v149, v95
    v_xor_b32 v96, v149, v96
    v_xor_b32 v97, v149, v97
    v_xor_b32 v98, v149, v98
    v_xor_b32 v99, v149, v99
    v_or3_b32 v60, v76, v77, v78
    v_or3_b32 v61, v79, v80, v81
    v_or3_b32 v62, v82, v83, v84
    v_or3_b32 v63, v85, v86, v87
    v_or3_b32 v64, v88, v89, v90
    v_or3_b32 v65, v91, v92, v93
    v_or3_b32 v66, v94, v95, v96
    v_or3_b32 v67, v97, v98, v99
    v_or3_b32 v68, v60, v61, v62
    v_or3_b32 v69, v63, v64, v65
    v_or3_b32 v70, v66, v67, v68
    v_or_b32 v71, v69, v70
    v_and_b32 v72, 63, v71
    v_cmp_ne_u32 vcc, 0, v72
    s_cbranch_vccnz L_guloop
L_guok:
    s_waitcnt vmcnt(0)
    v_add_f32 v80, v80, v76
    v_add_f32 v88, v88, v92
    v_add_f32 v81, v81, v77
    v_add_f32 v89, v89, v93
    v_add_f32 v82, v82, v78
    v_add_f32 v90, v90, v94
    v_add_f32 v83, v83, v79
    v_add_f32 v91, v91, v95
    v_add_f32 v80, v80, v84
    v_add_f32 v88, v88, v96
    v_add_f32 v81, v81, v85
    v_add_f32 v89, v89, v97
    v_add_f32 v82, v82, v86
    v_add_f32 v90, v90, v98
    v_add_f32 v83, v83, v87
    v_add_f32 v91, v91, v99
    v_cvt_pk_bf16_f32 v96, v80, v81
    v_lshlrev_b32 v80, 16, v96
    v_and_b32 v81, s43, v96
    v_cvt_pk_bf16_f32 v97, v82, v83
    v_lshlrev_b32 v82, 16, v97
    v_and_b32 v83, s43, v97
    v_cvt_pk_bf16_f32 v96, v88, v89
    v_lshlrev_b32 v88, 16, v96
    v_and_b32 v89, s43, v96
    v_cvt_pk_bf16_f32 v97, v90, v91
    v_lshlrev_b32 v90, 16, v97
    v_and_b32 v91, s43, v97
    s_mov_b32 s45, 0xbfb8aa3b
    v_mul_f32 v84, s45, v80
    v_mul_f32 v85, s45, v81
    v_mul_f32 v86, s45, v82
    v_mul_f32 v87, s45, v83
    v_exp_f32 v84, v84
    v_exp_f32 v85, v85
    v_exp_f32 v86, v86
    v_exp_f32 v87, v87
    v_add_f32 v84, 1.0, v84
    v_add_f32 v85, 1.0, v85
    v_add_f32 v86, 1.0, v86
    v_add_f32 v87, 1.0, v87
    v_rcp_f32 v84, v84
    v_rcp_f32 v85, v85
    v_rcp_f32 v86, v86
    v_rcp_f32 v87, v87
    v_mul_f32 v80, v80, v84
    v_mul_f32 v81, v81, v85
    v_mul_f32 v82, v82, v86
    v_mul_f32 v83, v83, v87
    v_cvt_pk_bf16_f32 v96, v80, v81
    v_lshlrev_b32 v80, 16, v96
    v_and_b32 v81, s43, v96
    v_cvt_pk_bf16_f32 v97, v82, v83
    v_lshlrev_b32 v82, 16, v97
    v_and_b32 v83, s43, v97
    v_mul_f32 v80, v80, v88
    v_mul_f32 v81, v81, v89
    v_mul_f32 v82, v82, v90
    v_mul_f32 v83, v83, v91
    v_cvt_pk_bf16_f32 v80, v80, v80
    v_cvt_pk_bf16_f32 v81, v81, v81
    v_cvt_pk_bf16_f32 v82, v82, v82
    v_cvt_pk_bf16_f32 v83, v83, v83
    ds_write_b128 v100, v[80:83] offset:11264
    s_mov_b64 exec, -1
L_trw:
    ds_read_b32 v5, v1 offset:5376
    s_waitcnt lgkmcnt(0)
    v_readfirstlane_b32 s59, v5
    s_nop 0
    s_cmp_ge_u32 s59, 8
    s_cbranch_scc1 L_trw_ok
    s_sleep 2
    s_branch L_trw
L_trw_ok:
    buffer_load_dwordx4 v[8:11], v2, s[8:11], s12 offen offset:0 nt
    buffer_load_dwordx4 v[12:15], v2, s[8:11], s12 offen offset:1152 nt
    buffer_load_dwordx4 v[16:19], v2, s[8:11], s12 offen offset:2304 nt
    buffer_load_dwordx4 v[20:23], v2, s[8:11], s12 offen offset:3456 nt
    buffer_load_dwordx4 v[24:27], v2, s[8:11], s13 offen offset:0 nt
    buffer_load_dwordx4 v[28:31], v2, s[8:11], s13 offen offset:1152 nt
    ds_read_b128 v[108:111], v106 offset:11264
    ds_read_b128 v[112:115], v106 offset:11280
    ds_read_b128 v[116:119], v106 offset:11392
    ds_read_b128 v[120:123], v106 offset:11408
    ds_read_b128 v[124:127], v106 offset:11520
    ds_read_b128 v[128:131], v106 offset:11536
    s_waitcnt lgkmcnt(0)
    v_and_b32 v60, v118, v160
    v_and_b32 v61, v118, v161
    v_and_b32 v62, v118, v162
    v_and_b32 v63, v118, v163
    v_and_b32 v64, v122, v160
    v_and_b32 v65, v122, v161
    v_and_b32 v66, v122, v162
    v_and_b32 v67, v122, v163
    v_and_b32 v68, v119, v160
    v_and_b32 v69, v119, v161
    v_and_b32 v70, v119, v162
    v_and_b32 v71, v119, v163
    v_and_b32 v72, v123, v160
    v_and_b32 v73, v123, v161
    v_and_b32 v74, v123, v162
    v_and_b32 v75, v123, v163
    v_and_b32 v76, v124, v160
    v_and_b32 v77, v124, v161
    v_and_b32 v78, v124, v162
    v_and_b32 v79, v124, v163
    v_and_b32 v80, v128, v160
    v_and_b32 v81, v128, v161
    v_and_b32 v82, v128, v162
    v_and_b32 v83, v128, v163
    v_and_b32 v84, v125, v160
    v_and_b32 v85, v125, v161
    v_and_b32 v86, v125, v162
    v_and_b32 v87, v125, v163
    v_and_b32 v88, v129, v160
    v_and_b32 v89, v129, v161
    v_and_b32 v90, v129, v162
    v_and_b32 v91, v129, v163
    v_and_b32 v92, v126, v160
    v_and_b32 v93, v126, v161
    v_and_b32 v94, v126, v162
    v_and_b32 v95, v126, v163
    v_and_b32 v96, v130, v160
    v_and_b32 v97, v130, v161
    v_and_b32 v98, v130, v162
    v_and_b32 v99, v130, v163
    v_and_b32 v132, v127, v160
    v_and_b32 v133, v127, v161
    v_and_b32 v134, v127, v162
    v_and_b32 v135, v127, v163
    v_and_b32 v136, v131, v160
    v_and_b32 v137, v131, v161
    v_and_b32 v138, v131, v162
    v_and_b32 v139, v131, v163
L_trw2:
    ds_read_b32 v5, v1 offset:5380
    s_waitcnt lgkmcnt(0)
    v_readfirstlane_b32 s59, v5
    s_nop 0
    s_cmp_ge_u32 s59, 9
    s_cbranch_scc1 L_trw2_ok
    s_sleep 1
    s_branch L_trw2
L_trw2_ok:
    buffer_load_dwordx4 v[32:35], v2, s[8:11], s13 offen offset:2304 nt
    buffer_load_dwordx4 v[36:39], v2, s[8:11], s13 offen offset:3456 nt
    buffer_load_dwordx4 v[40:43], v2, s[8:11], s14 offen offset:0 nt
    buffer_load_dwordx4 v[44:47], v2, s[8:11], s14 offen offset:1152 nt
    buffer_load_dwordx4 v[48:51], v2, s[8:11], s14 offen offset:2304 nt
    buffer_load_dwordx4 v[52:55], v2, s[8:11], s14 offen offset:3456 nt
    v_and_b32 v152, v108, v160
    v_and_b32 v153, v108, v161
    v_and_b32 v154, v108, v162
    v_and_b32 v155, v108, v163
    v_and_b32 v156, v112, v160
    v_and_b32 v157, v112, v161
    v_and_b32 v158, v112, v162
    v_and_b32 v159, v112, v163
    s_waitcnt vmcnt(11)
    v_mfma_f32_16x16x32_bf16 v[140:143], v[152:155], v[8:11], 0
    v_mfma_f32_16x16x32_bf16 v[144:147], v[156:159], v[8:11], 0
    v_and_b32 v152, v109, v160
    v_and_b32 v153, v109, v161
    v_and_b32 v154, v109, v162
    v_and_b32 v155, v109, v163
    v_and_b32 v156, v113, v160
    v_and_b32 v157, v113, v161
    v_and_b32 v158, v113, v162
    v_and_b32 v159, v113, v163
    s_waitcnt vmcnt(10)
    v_mfma_f32_16x16x32_bf16 v[140:143], v[152:155], v[12:15], v[140:143]
    v_mfma_f32_16x16x32_bf16 v[144:147], v[156:159], v[12:15], v[144:147]
    v_and_b32 v152, v110, v160
    v_and_b32 v153, v110, v161
    v_and_b32 v154, v110, v162
    v_and_b32 v155, v110, v163
    v_and_b32 v156, v114, v160
    v_and_b32 v157, v114, v161
    v_and_b32 v158, v114, v162
    v_and_b32 v159, v114, v163
    s_waitcnt vmcnt(9)
    v_mfma_f32_16x16x32_bf16 v[140:143], v[152:155], v[16:19], v[140:143]
    v_mfma_f32_16x16x32_bf16 v[144:147], v[156:159], v[16:19], v[144:147]
    v_and_b32 v152, v111, v160
    v_and_b32 v153, v111, v161
    v_and_b32 v154, v111, v162
    v_and_b32 v155, v111, v163
    v_and_b32 v156, v115, v160
    v_and_b32 v157, v115, v161
    v_and_b32 v158, v115, v162
    v_and_b32 v159, v115, v163
    s_waitcnt vmcnt(8)
    v_mfma_f32_16x16x32_bf16 v[140:143], v[152:155], v[20:23], v[140:143]
    v_mfma_f32_16x16x32_bf16 v[144:147], v[156:159], v[20:23], v[144:147]
    v_and_b32 v152, v116, v160
    v_and_b32 v153, v116, v161
    v_and_b32 v154, v116, v162
    v_and_b32 v155, v116, v163
    v_and_b32 v156, v120, v160
    v_and_b32 v157, v120, v161
    v_and_b32 v158, v120, v162
    v_and_b32 v159, v120, v163
    s_waitcnt vmcnt(7)
    v_mfma_f32_16x16x32_bf16 v[140:143], v[152:155], v[24:27], v[140:143]
    v_mfma_f32_16x16x32_bf16 v[144:147], v[156:159], v[24:27], v[144:147]
    v_and_b32 v152, v117, v160
    v_and_b32 v153, v117, v161
    v_and_b32 v154, v117, v162
    v_and_b32 v155, v117, v163
    v_and_b32 v156, v121, v160
    v_and_b32 v157, v121, v161
    v_and_b32 v158, v121, v162
    v_and_b32 v159, v121, v163
    s_waitcnt vmcnt(6)
    v_mfma_f32_16x16x32_bf16 v[140:143], v[152:155], v[28:31], v[140:143]
    v_mfma_f32_16x16x32_bf16 v[144:147], v[156:159], v[28:31], v[144:147]
    s_waitcnt vmcnt(5)
    v_mfma_f32_16x16x32_bf16 v[140:143], v[60:63], v[32:35], v[140:143]
    v_mfma_f32_16x16x32_bf16 v[144:147], v[64:67], v[32:35], v[144:147]
    s_waitcnt vmcnt(4)
    v_mfma_f32_16x16x32_bf16 v[140:143], v[68:71], v[36:39], v[140:143]
    v_mfma_f32_16x16x32_bf16 v[144:147], v[72:75], v[36:39], v[144:147]
    s_waitcnt vmcnt(3)
    v_mfma_f32_16x16x32_bf16 v[140:143], v[76:79], v[40:43], v[140:143]
    v_mfma_f32_16x16x32_bf16 v[144:147], v[80:83], v[40:43], v[144:147]
    s_waitcnt vmcnt(2)
    v_mfma_f32_16x16x32_bf16 v[140:143], v[84:87], v[44:47], v[140:143]
    v_mfma_f32_16x16x32_bf16 v[144:147], v[88:91], v[44:47], v[144:147]
    s_waitcnt vmcnt(1)
    v_mfma_f32_16x16x32_bf16 v[140:143], v[92:95], v[48:51], v[140:143]
    v_mfma_f32_16x16x32_bf16 v[144:147], v[96:99], v[48:51], v[144:147]
    s_waitcnt vmcnt(0)
    v_mfma_f32_16x16x32_bf16 v[140:143], v[132:135], v[52:55], v[140:143]
    v_mfma_f32_16x16x32_bf16 v[144:147], v[136:139], v[52:55], v[144:147]
L_fred:
    s_mov_b32 vcc_lo, 0xff00ff00
    s_mov_b32 vcc_hi, 0xff00ff00
    v_mov_b32 v5, 1
    s_nop 4
    v_cndmask_b32 v140, v140, v144, vcc
    v_cndmask_b32 v141, v141, v145, vcc
    v_cndmask_b32 v142, v142, v146, vcc
    v_cndmask_b32 v143, v143, v147, vcc
    ds_write_b128 v107, v[140:143] offset:18432
    s_mov_b64 exec, 1
    ds_add_rtn_u32 v5, v1, v5 offset:5392
    s_mov_b64 exec, -1
    ds_read_b128 v[8:11], v103 offset:18432
    ds_read_b128 v[12:15], v103 offset:19456
    ds_read_b128 v[16:19], v103 offset:20480
    ds_read_b128 v[20:23], v103 offset:21504
    s_waitcnt lgkmcnt(4)
    v_readfirstlane_b32 s4, v5
    s_nop 0
    s_cmp_lg_u32 s4, 3
    s_cbranch_scc1 L_auxend
    s_waitcnt lgkmcnt(2)
    v_pk_add_f32 v[8:9], v[8:9], v[12:13]
    v_pk_add_f32 v[10:11], v[10:11], v[14:15]
    s_waitcnt lgkmcnt(0)
    v_pk_add_f32 v[16:17], v[16:17], v[20:21]
    v_pk_add_f32 v[18:19], v[18:19], v[22:23]
    v_pk_add_f32 v[8:9], v[8:9], v[16:17]
    v_pk_add_f32 v[10:11], v[10:11], v[18:19]
    s_nop 0
    v_add_f32_dpp v8, v8, v8 row_ror:8 row_mask:0xf bank_mask:0xf
    v_add_f32_dpp v9, v9, v9 row_ror:8 row_mask:0xf bank_mask:0xf
    v_add_f32_dpp v10, v10, v10 row_ror:8 row_mask:0xf bank_mask:0xf
    v_add_f32_dpp v11, v11, v11 row_ror:8 row_mask:0xf bank_mask:0xf
    s_mov_b32 exec_lo, 0x00ff00ff
    s_mov_b32 exec_hi, 0x00ff00ff
    v_bfi_b32 v8, s41, v150, v8
    v_bfi_b32 v9, s41, v150, v9
    v_bfi_b32 v10, s41, v150, v10
    v_bfi_b32 v11, s41, v150, v11
    buffer_store_dwordx4 v[8:11], v101, s[60:63], s57 offen sc1
L_auxend:
    s_endpgm
L_red:
    s_lshl_b32 s5, s4, 12
    s_add_u32 s12, s5, 655360
    v_lshlrev_b32 v4, 4, v0
    v_and_b32 v6, 7, v0
    v_lshlrev_b32 v6, 3, v6
    v_bfe_u32 v7, v0, 4, 1
    v_lshl_add_u32 v6, v7, 2, v6
    s_lshl_b32 s5, s4, 6
    v_add_u32 v6, s5, v6
    global_load_dword v100, v6, s[16:17]
    s_mov_b32 s8, s34
    s_mov_b32 s9, s35
    s_movk_i32 s10, 2304
    s_mov_b32 s14, 30015
L_wred:
    ds_read_b32 v5, v1 offset:5380
    s_waitcnt lgkmcnt(0)
    v_readfirstlane_b32 s59, v5
    s_nop 0
    s_cmp_ge_u32 s59, 9
    s_cbranch_scc1 L_wred_ok
    s_sleep 2
    s_branch L_wred
L_wred_ok:
L_rp:
    buffer_load_dwordx4 v[24:27], v4, s[60:63], s12 offen sc1
    s_sub_u32 s14, s14, 1
    s_cbranch_scc1 L_rl
    s_waitcnt vmcnt(0)
    v_xor_b32 v24, v150, v24
    v_xor_b32 v25, v150, v25
    v_or_b32 v60, v24, v25
    v_and_b32 v61, s41, v60
    v_cmp_ne_u32 vcc, 0, v61
    s_nop 0
    s_bcnt1_i32_b64 s5, vcc
    s_cmp_le_u32 s5, 24
    s_cbranch_scc1 L_rl
    s_sleep 2
    s_branch L_rp
L_rl:
    buffer_load_dwordx4 v[24:27], v4, s[60:63], s12 offen offset:0 sc1
    buffer_load_dwordx4 v[28:31], v4, s[60:63], s12 offen offset:1024 sc1
    buffer_load_dwordx4 v[32:35], v4, s[60:63], s12 offen offset:2048 sc1
    v_mov_b32 v36, v150
    v_mov_b32 v37, v150
    v_mov_b32 v38, v150
    v_mov_b32 v39, v150
    s_mov_b32 exec_hi, 0
    buffer_load_dwordx4 v[36:39], v4, s[60:63], s12 offen offset:3072 sc1
    s_mov_b64 exec, -1
    s_sub_u32 s14, s14, 1
    s_cbranch_scc1 L_rok
    s_waitcnt vmcnt(0)
    v_xor_b32 v24, v150, v24
    v_xor_b32 v25, v150, v25
    v_xor_b32 v26, v150, v26
    v_xor_b32 v27, v150, v27
    v_xor_b32 v28, v150, v28
    v_xor_b32 v29, v150, v29
    v_xor_b32 v30, v150, v30
    v_xor_b32 v31, v150, v31
    v_xor_b32 v32, v150, v32
    v_xor_b32 v33, v150, v33
    v_xor_b32 v34, v150, v34
    v_xor_b32 v35, v150, v35
    v_xor_b32 v36, v150, v36
    v_xor_b32 v37, v150, v37
    v_xor_b32 v38, v150, v38
    v_xor_b32 v39, v150, v39
    v_or3_b32 v60, v24, v25, v26
    v_or3_b32 v61, v27, v28, v29
    v_or3_b32 v62, v30, v31, v32
    v_or3_b32 v63, v33, v34, v35
    v_or3_b32 v64, v36, v37, v38
    v_or3_b32 v65, v39, v60, v61
    v_or3_b32 v66, v62, v63, v64
    v_or_b32 v67, v65, v66
    v_and_b32 v68, s41, v67
    v_cmp_ne_u32 vcc, 0, v68
    s_cbranch_vccnz L_rl
L_rok:
    s_waitcnt vmcnt(0)
    v_pk_add_f32 v[24:25], v[24:25], v[28:29]
    v_pk_add_f32 v[26:27], v[26:27], v[30:31]
    v_pk_add_f32 v[32:33], v[32:33], v[36:37]
    v_pk_add_f32 v[34:35], v[34:35], v[38:39]
    v_lshlrev_b32 v10, 16, v100
    v_permlane32_swap_b32 v24, v32
    v_permlane32_swap_b32 v25, v33
    v_permlane32_swap_b32 v26, v34
    v_permlane32_swap_b32 v27, v35
    v_pk_add_f32 v[24:25], v[24:25], v[32:33]
    v_pk_add_f32 v[26:27], v[26:27], v[34:35]
    v_and_b32 v11, s43, v100
    s_nop 0
    v_permlane16_swap_b32 v24, v26
    v_permlane16_swap_b32 v25, v27
    v_pk_add_f32 v[8:9], v[24:25], v[26:27]
    s_nop 1
    v_add_f32_dpp v8, v8, v8 row_ror:8 row_mask:0xf bank_mask:0xf
    v_add_f32_dpp v9, v9, v9 row_ror:8 row_mask:0xf bank_mask:0xf
    v_cvt_pk_bf16_f32 v8, v8, v9
    v_mov_b32 v9, v8
    s_nop 1
    v_permlane32_swap_b32 v8, v9
    v_lshlrev_b32 v12, 16, v8
    v_and_b32 v13, s43, v8
    v_pk_add_f32 v[10:11], v[10:11], v[12:13]
    v_lshlrev_b32 v12, 16, v9
    v_cvt_pk_bf16_f32 v8, v10, v11
    v_and_b32 v13, s43, v9
    v_lshlrev_b32 v10, 16, v8
    v_and_b32 v11, s43, v8
    v_pk_add_f32 v[10:11], v[10:11], v[12:13]
    s_mov_b64 exec, 0x00ff00ff
    v_cvt_pk_bf16_f32 v10, v10, v11
    buffer_store_dword v10, v6, s[8:11], 0 offen
    s_cmp_lg_u32 s4, 0
    s_cbranch_scc1 L_rend
    s_mov_b64 exec, 1
    v_mov_b32 v11, s40
    buffer_store_dword v11, v1, s[60:63], 0 offen offset:0 sc1
L_rend:
L_end:
    s_endpgm
.section .rodata,"a"
.p2align 6
.amdhsa_kernel parallel_sum__sliding_block_cached__glu_gated_swiglu__decode_kernel
  .amdhsa_next_free_vgpr 168
  .amdhsa_next_free_sgpr 66
  .amdhsa_accum_offset 168
  .amdhsa_group_segment_fixed_size 0
  .amdhsa_kernarg_size 96
  .amdhsa_user_sgpr_count 2
  .amdhsa_user_sgpr_kernarg_segment_ptr 1
  .amdhsa_system_sgpr_workgroup_id_x 1
.end_amdhsa_kernel
```
